```python
import torch

def _softmax(x, axis=-1):
    return torch.softmax(x, dim=axis)
def _gelu(x):
    return torch.nn.functional.gelu(x, approximate="tanh")
def _silu(x):
    return torch.nn.functional.silu(x)
def _sigmoid(x):
    return torch.sigmoid(x)
def _layernorm(x, axis=-1, eps=1e-5):
    m = x.mean(dim=axis, keepdim=True)
    v = x.var(dim=axis, keepdim=True, unbiased=False)
    return (x - m) / torch.sqrt(v + eps)
def _scatter_add(tgt, idx, src, axis=0):
    return tgt.clone().index_add_(axis, idx, src)
def _segment_sum(src, seg, n):
    out = torch.zeros((n,) + src.shape[1:], dtype=src.dtype)
    return out.index_add_(0, seg, src)
def _pad(x, pw):
    flat = tuple(v for pair in reversed(pw) for v in pair)
    return torch.nn.functional.pad(x, flat)

kernel_name = 'interleave_layers__linear_attn_block__glu_gated_bilinear__prompt'

def setup_inputs():

    _w = (lambda a: (lambda t: t.to(torch.bfloat16) if t.is_floating_point() else t)(torch.as_tensor(a)))
    def _A_setup():
        B, S, D = 1, 2048, 512
        return {
            "x": _w((lambda *s: torch.randn(*s, dtype=torch.bfloat16) * 0.05)(B, S, D)),
            "wqkv": _w((lambda *s: torch.randn(*s, dtype=torch.bfloat16) * 0.05)(D, 3 * D)),
            "wo": _w((lambda *s: torch.randn(*s, dtype=torch.bfloat16) * 0.05)(D, D)),
        }
    _A_in = _A_setup()

    def _B_setup():
        B, S, D, F = 1, 2048, 512, 1792
        return {
            "x": _w((lambda *s: torch.randn(*s, dtype=torch.bfloat16) * 0.05)(B, S, D)),
            "w_gate": _w((lambda *s: torch.randn(*s, dtype=torch.bfloat16) * 0.4)(D, F) * (D ** -0.5)),
            "w_up": _w((lambda *s: torch.randn(*s, dtype=torch.bfloat16) * 0.4)(D, F) * (D ** -0.5)),
            "w_down": _w((lambda *s: torch.randn(*s, dtype=torch.bfloat16) * 0.4)(F, D) * (F ** -0.5)),
        }
    _B_in = _B_setup()

    return {
        "A_x": _A_in["x"],
        "A_wqkv": _A_in["wqkv"],
        "A_wo": _A_in["wo"],
        "B_x": _B_in["x"],
        "B_w_gate": _B_in["w_gate"],
        "B_w_up": _B_in["w_up"],
        "B_w_down": _B_in["w_down"],
    }

def reference(A_x, A_wqkv, A_wo, B_x, B_w_gate, B_w_up, B_w_down):
    def _A_ref(x, wqkv, wo):
        B, S, D = x.shape
        H = 32; Dh = D // H
        qkv = (lambda x, *d: x.permute(*d))((x @ wqkv).reshape(B, S, 3, H, Dh), 2, 0, 3, 1, 4)
        q, k, v = qkv[0], qkv[1], qkv[2]
        phi = lambda t: torch.where(t > 0, t + 1, torch.exp(t)) + 1e-6
        pq, pk = phi(q), phi(k)
        kv = torch.einsum("bhsd,bhse->bhde", pk, v)
        z = torch.einsum("bhsd->bhd", pk)
        num = torch.einsum("bhqd,bhde->bhqe", pq, kv)
        den = torch.einsum("bhqd,bhd->bhq", pq, z)[..., None] + 1e-6
        o = num / den
        return (lambda x, *d: x.permute(*d))(o, 0, 2, 1, 3).reshape(B, S, D) @ wo

    def _B_ref(x, w_gate, w_up, w_down):
        g = torch.einsum("bsd,df->bsf", x, w_gate)
        u = torch.einsum("bsd,df->bsf", x, w_up)
        h = g * u
        return torch.einsum("bsf,fd->bsd", h, w_down)

    x = A_x
    x = x + _A_ref(_layernorm(x, axis=-1), A_wqkv, A_wo)
    x = x + _B_ref(_layernorm(x, axis=-1), B_w_gate, B_w_up, B_w_down)
    x = x + _A_ref(_layernorm(x, axis=-1), A_wqkv, A_wo)
    x = x + _B_ref(_layernorm(x, axis=-1), B_w_gate, B_w_up, B_w_down)
    return x
```

```asm
; @launch grid=(256,1,1) block=(256,1,1) lds=163840
.amdgcn_target "amdgcn-amd-amdhsa--gfx950"
.text
.globl interleave_layers__linear_attn_block__glu_gated_bilinear__prompt_kernel
.p2align 8
.type interleave_layers__linear_attn_block__glu_gated_bilinear__prompt_kernel,@function
interleave_layers__linear_attn_block__glu_gated_bilinear__prompt_kernel:
  s_cmp_ge_u32 s2, 256
  s_cbranch_scc1 L_main_end_1
  s_load_dwordx16 s[76:91], s[0:1], 0
  s_load_dwordx4 s[92:95], s[0:1], 64
  v_lshrrev_b32 v27, 6, v0
  v_and_b32 v0, 63, v0
  v_readfirstlane_b32 s14, v27
  v_lshlrev_b32 v1, 4, v0
  s_getpc_b64 s[64:65]
L_main_pc_2:
  s_sub_u32 s64, s64, L_main_pc_2-interleave_layers__linear_attn_block__glu_gated_bilinear__prompt_kernel
  s_subb_u32 s65, s65, 0
  s_bfe_u32 s62, s2, 131075
  s_lshl_b32 s62, s62, 13
  v_lshlrev_b32 v27, 11, v27
  v_lshl_add_u32 v27, v0, 7, v27
  v_add_u32 v27, s62, v27
  s_mov_b32 s62, L_code_end-interleave_layers__linear_attn_block__glu_gated_bilinear__prompt_kernel-4
  v_min_u32 v27, s62, v27
  s_mov_b64 exec, 0xffff
  global_load_dword v245, v27, s[64:65]
  s_mov_b64 exec, -1
  s_and_b32 s50, s2, 7
  s_lshr_b32 s51, s2, 3
  s_lshl_b32 s12, s50, 1
  s_lshr_b32 s52, s51, 4
  s_add_u32 s12, s12, s52
  s_and_b32 s13, s51, 15
  s_mov_b32 s7, 0x20000
  s_mov_b32 s11, 0x20000
  s_mov_b32 s71, 0x20000
  s_mov_b32 s75, 0x20000
  s_mov_b32 s99, 0x20000
  s_mov_b32 s6, 268435456
  s_mov_b32 s10, 2097152
  s_mov_b32 s70, 2097152
  s_mov_b32 s74, 1572864
  s_mov_b64 vcc, 0
  s_lshl_b32 s15, s14, 12
  s_lshl_b32 s50, s12, 2
  s_add_u32 s50, s50, s14
  s_lshl_b32 s16, s50, 15
  s_lshl_b32 s17, s50, 12
  s_lshr_b32 s49, s12, 1
  s_mul_i32 s49, s49, 1
  s_add_u32 s49, s49, s13
  s_lshl_b32 s43, s14, 14
  s_add_u32 s43, s43, 98304
  v_lshlrev_b32 v4, 2, v0
  v_lshrrev_b32 v27, 4, v0
  v_and_b32 v28, 15, v0
  v_xor_b32 v28, v28, v27
  v_lshlrev_b32 v28, 4, v28
  v_lshl_add_u32 v224, v27, 10, v28
  v_xor_b32 v225, 64, v224
  v_xor_b32 v226, 128, v224
  v_xor_b32 v227, 192, v224
  v_lshrrev_b32 v27, 2, v0
  v_mul_u32_u24 v27, 3072, v27
  v_and_b32 v28, 3, v0
  v_lshl_add_u32 v228, v28, 4, v27
  s_waitcnt lgkmcnt(0)
  s_mov_b32 s68, s76
  s_and_b32 s69, s77, 0xffff
  s_mov_b32 s72, s78
  s_and_b32 s73, s79, 0xffff
  s_mov_b32 s4, s94
  s_and_b32 s5, s95, 0xffff
  s_mov_b32 s8, s90
  s_and_b32 s9, s91, 0xffff
  v_mov_b32 v249, 0
  s_cmp_lg_u32 s2, 0
  s_cbranch_scc1 L_main_nz_3
  v_lshlrev_b32 v28, 8, v0
  s_lshl_b32 s62, s14, 14
  s_add_u32 s62, s62, 0
  buffer_store_dword v249, v28, s[4:7], s62 offen sc1
  v_mov_b32 v32, 0
  v_mov_b32 v33, 0
  v_mov_b32 v34, 0
  v_mov_b32 v35, 0
  s_lshl_b32 s62, s14, 11
  s_add_u32 s62, s62, 65536
  buffer_store_dwordx4 v[32:35], v1, s[4:7], s62 offen sc1
  buffer_store_dwordx4 v[32:35], v1, s[4:7], s62 offen offset:1024 sc1
L_main_nz_3:
  s_add_u32 s46, s49, 0
  s_and_b32 s46, s46, 3
  s_lshl_b32 s44, s46, 8
  s_add_u32 s44, s44, s16
  s_lshl_b32 s46, s46, 3
  s_add_u32 s46, s46, s14
  s_mul_i32 s45, s46, 49152
  s_lshl_b32 s46, s13, 6
  s_add_u32 s45, s45, s46
  s_lshl_b32 s47, s14, 10
  s_add_u32 s48, s44, 0
  s_add_u32 m0, s43, 0
  s_nop 0
  buffer_load_dwordx4 v224, s[68:71], s48 offen lds
  s_add_u32 s48, s44, 4096
  s_add_u32 m0, s43, 1024
  s_nop 0
  buffer_load_dwordx4 v225, s[68:71], s48 offen lds
  s_add_u32 s48, s45, 1024
  s_add_u32 m0, s47, 0
  s_nop 0
  buffer_load_dwordx4 v228, s[72:75], s48 offen lds
  s_add_u32 s48, s44, 8192
  s_add_u32 m0, s43, 2048
  s_nop 0
  buffer_load_dwordx4 v226, s[68:71], s48 offen lds
  s_add_u32 s48, s44, 12288
  s_add_u32 m0, s43, 3072
  s_nop 0
  buffer_load_dwordx4 v227, s[68:71], s48 offen lds
  s_add_u32 s48, s45, 2048
  s_add_u32 m0, s47, 32768
  s_nop 0
  buffer_load_dwordx4 v228, s[72:75], s48 offen lds
  s_add_u32 s48, s44, 16384
  s_add_u32 m0, s43, 4096
  s_nop 0
  buffer_load_dwordx4 v224, s[68:71], s48 offen lds
  s_add_u32 s48, s44, 20480
  s_add_u32 m0, s43, 5120
  s_nop 0
  buffer_load_dwordx4 v225, s[68:71], s48 offen lds
  s_add_u32 s48, s45, 197632
  s_add_u32 m0, s47, 4096
  s_nop 0
  buffer_load_dwordx4 v228, s[72:75], s48 offen lds
  s_add_u32 s48, s44, 24576
  s_add_u32 m0, s43, 6144
  s_nop 0
  buffer_load_dwordx4 v226, s[68:71], s48 offen lds
  s_add_u32 s48, s44, 28672
  s_add_u32 m0, s43, 7168
  s_nop 0
  buffer_load_dwordx4 v227, s[68:71], s48 offen lds
  s_add_u32 s48, s45, 198656
  s_add_u32 m0, s47, 36864
  s_nop 0
  buffer_load_dwordx4 v228, s[72:75], s48 offen lds
  s_mov_b32 s96, s80
  s_and_b32 s97, s81, 0xffff
  s_mov_b32 s98, 524288
  s_and_b32 s50, s13, 7
  s_lshl_b32 s50, s50, 1
  s_lshr_b32 s51, s13, 3
  s_add_u32 s50, s50, s51
  s_lshl_b32 s51, s12, 1
  s_add_u32 s51, s51, s14
  s_cmp_ge_u32 s14, 2
  s_cselect_b32 s52, 268435456, 0
  s_lshl_b32 s53, s51, 14
  s_lshl_b32 s54, s50, 6
  s_add_u32 s53, s53, s54
  s_add_u32 s53, s53, s52
  s_lshl_b32 s65, s50, 15
  s_lshl_b32 s51, s51, 10
  s_add_u32 s65, s65, s51
  s_add_u32 s65, s65, 1695744
  s_add_u32 s3, s65, s52
  v_lshrrev_b32 v27, 2, v0
  v_lshlrev_b32 v27, 10, v27
  v_and_b32 v28, 3, v0
  v_lshl_add_u32 v27, v28, 4, v27
  s_lshl_b32 s50, s14, 10
  s_add_u32 m0, s50, 65536
  s_nop 0
  buffer_load_dwordx4 v27, s[96:99], s53 offen lds
  v_add_u32 v2, 65536, v1
  v_add_u32 v3, 131072, v1
  s_mul_i32 s18, s13, 98304
  s_add_u32 s18, s18, s15
  s_mul_i32 s20, s13, 3072
  s_mul_i32 s19, s13, 229376
  s_add_u32 s19, s19, s15
  s_mul_i32 s21, s13, 7168
  s_lshl_b32 s51, s13, 11
  s_add_u32 s22, s16, s51
  s_lshr_b32 s50, s16, 15
  s_mul_i32 s23, s50, 114688
  s_add_u32 s23, s23, s21
  s_lshl_b32 s50, s12, 2
  s_lshr_b32 s51, s13, 3
  s_lshl_b32 s51, s51, 1
  s_add_u32 s50, s50, s51
  s_lshr_b32 s51, s14, 1
  s_add_u32 s50, s50, s51
  s_xor_b32 s51, s50, 1
  s_and_b32 s52, s13, 7
  s_lshl_b32 s52, s52, 1
  s_and_b32 s53, s14, 1
  s_add_u32 s52, s52, s53
  s_xor_b32 s53, s52, 1
  s_mul_i32 s54, s14, 28672
  s_lshl_b32 s55, s14, 13
  s_lshl_b32 s24, s50, 15
  s_add_u32 s24, s24, s55
  s_lshl_b32 s25, s51, 15
  s_add_u32 s25, s25, s55
  s_lshl_b32 s26, s52, 15
  s_add_u32 s26, s26, s55
  s_lshl_b32 s27, s53, 15
  s_add_u32 s27, s27, s55
  s_mul_i32 s28, s50, 114688
  s_add_u32 s28, s28, s54
  s_mul_i32 s29, s51, 114688
  s_add_u32 s29, s29, s54
  s_mul_i32 s30, s52, 114688
  s_add_u32 s30, s30, s54
  s_mul_i32 s31, s53, 114688
  s_add_u32 s31, s31, s54
  s_lshl_b32 s32, s50, 15
  s_lshl_b32 s55, s52, 11
  s_add_u32 s32, s32, s55
  s_lshl_b32 s33, s50, 12
  s_lshl_b32 s55, s52, 8
  s_add_u32 s33, s33, s55
  s_lshl_b32 s38, s50, 15
  s_lshl_b32 s55, s52, 6
  s_add_u32 s38, s38, s55
  s_mov_b32 s34, 0
  s_lshl_b32 s101, s50, 6
  s_lshl_b32 s55, s52, 2
  s_add_u32 s101, s101, s55
  s_add_u32 s101, s101, 69632
  s_bitset0_b32 s50, 0
  s_lshl_b32 s50, s50, 6
  s_lshl_b32 s55, s14, 4
  s_add_u32 s50, s50, s55
  s_add_u32 s50, s50, 65536
  v_bfe_u32 v27, v0, 2, 1
  v_lshlrev_b32 v27, 6, v27
  v_and_b32 v28, 3, v0
  v_lshl_add_u32 v27, v28, 2, v27
  v_add_u32 v9, s50, v27
  s_lshr_b32 s50, s16, 9
  s_lshl_b32 s55, s13, 2
  s_add_u32 s100, s50, s55
  s_add_u32 s100, s100, 65536
  s_add_u32 s50, s50, 69632
  v_and_b32 v27, 15, v0
  v_lshlrev_b32 v27, 2, v27
  v_add_u32 v10, s50, v27
  s_lshl_b32 s35, s13, 15
  s_lshl_b32 s55, s14, 9
  s_add_u32 s35, s35, s55
  s_lshl_b32 s41, s13, 11
  s_lshl_b32 s55, s14, 5
  s_add_u32 s41, s41, s55
  s_add_u32 s41, s41, 39321600
  s_lshl_b32 s36, s12, 8
  s_lshl_b32 s37, s13, 8
  v_and_b32 v27, 31, v0
  v_lshlrev_b32 v27, 3, v27
  v_lshrrev_b32 v28, 5, v0
  v_lshl_add_u32 v11, v28, 9, v27
  s_and_b32 s91, s12, 1
  s_lshl_b32 s91, s91, 15
  s_add_u32 s91, s91, s19
  s_add_u32 s91, s91, s15
  s_mov_b32 s39, 901882814
  s_mov_b32 s40, 1060205080
  s_mov_b32 s56, -1
  s_cmp_eq_u32 s14, 0
  s_cselect_b32 s57, 0xff, 0
  s_mov_b32 s58, 0xffff0000
  s_mov_b32 s59, 0xffff0000
  s_mov_b32 s60, -1
  s_mov_b32 s61, 0
  v_mov_b32 v8, 0x3f803f80
  s_mul_i32 s62, s14, 2304
  s_add_u32 s62, s62, 151552
  v_lshrrev_b32 v28, 5, v0
  v_lshlrev_b32 v29, 5, v28
  v_add_u32 v29, s62, v29
  v_and_b32 v27, 31, v0
  v_lshl_add_u32 v5, v27, 6, v29
  v_bfe_u32 v27, v0, 4, 1
  v_lshl_add_u32 v6, v27, 6, v29
  v_add_u32 v6, 2048, v6
  s_lshl_b32 s62, s14, 9
  v_add_u32 v27, s62, v1
  v_add_u32 v29, 1536, v1
  v_cndmask_b32 v7, v29, v27, s[60:61]
  v_min_u32 v7, 2160, v7
  v_add_u32 v7, 151552, v7
  s_lshl_b32 s50, s13, 4
  s_add_u32 s50, s50, s12
  s_lshl_b32 s62, s50, 11
  s_add_u32 s62, s62, 38797312
  v_add_u32 v27, s62, v27
  s_lshl_b32 s62, s50, 7
  s_add_u32 s62, s62, 39319552
  v_add_u32 v29, s62, v29
  v_cndmask_b32 v128, v29, v27, s[60:61]
  v_and_b32 v27, 31, v0
  v_lshlrev_b32 v27, 4, v27
  v_lshl_add_u32 v129, v28, 11, v27
  v_lshrrev_b32 v27, 2, v0
  v_lshlrev_b32 v27, 7, v27
  v_and_b32 v29, 3, v0
  v_lshl_add_u32 v130, v29, 3, v27
  s_lshr_b32 s62, s14, 1
  s_mul_i32 s62, s62, 544
  s_add_u32 s62, s62, 160768
  s_and_b32 s50, s14, 1
  s_lshl_b32 s51, s50, 8
  s_add_u32 s51, s51, s62
  v_and_b32 v27, 31, v0
  v_lshlrev_b32 v27, 3, v27
  v_lshl_add_u32 v27, v28, 2, v27
  v_add_u32 v16, s51, v27
  s_lshl_b32 s51, s50, 4
  s_add_u32 s51, s51, s62
  s_add_u32 s51, s51, 512
  v_lshlrev_b32 v27, 2, v29
  v_lshl_add_u32 v27, v28, 1, v27
  v_add_u32 v131, s51, v27
  v_and_b32 v27, 31, v0
  v_min_u32 v27, 16, v27
  v_lshlrev_b32 v27, 5, v27
  v_lshl_add_u32 v27, v28, 4, v27
  v_add_u32 v17, 160768, v27
  s_lshl_b32 s62, s14, 8
  s_add_u32 s62, s62, 147456
  v_add_u32 v24, s62, v4
  v_lshlrev_b32 v28, 4, v28
  v_add_u32 v25, s62, v28
  s_xor_b32 s62, s14, 1
  s_mul_i32 s62, s62, 12288
  s_add_u32 s62, s62, 98304
  v_add_u32 v12, s62, v1
  s_xor_b32 s62, s14, 2
  s_mul_i32 s62, s62, 12288
  s_add_u32 s62, s62, 102400
  v_add_u32 v13, s62, v1
  s_xor_b32 s62, s14, 3
  s_mul_i32 s62, s62, 12288
  s_add_u32 s62, s62, 106496
  v_add_u32 v14, s62, v1
  s_mul_i32 s62, s14, 12288
  s_add_u32 s62, s62, 98304
  v_add_u32 v15, s62, v1
  v_and_b32 v27, 31, v0
  v_lshlrev_b32 v27, 10, v27
  v_add_u32 v26, v27, v28
  v_and_b32 v27, 15, v0
  v_lshrrev_b32 v29, 5, v0
  v_xor_b32 v27, v27, v29
  v_lshlrev_b32 v27, 4, v27
  v_and_b32 v29, 31, v0
  v_lshl_add_u32 v27, v29, 8, v27
  v_add_u32 v232, s43, v27
  v_xor_b32 v233, 32, v232
  v_xor_b32 v234, 64, v232
  v_xor_b32 v235, 96, v232
  v_xor_b32 v236, 128, v232
  v_xor_b32 v237, 160, v232
  v_xor_b32 v238, 192, v232
  v_xor_b32 v239, 224, v232
  v_lshrrev_b32 v27, 5, v0
  v_lshlrev_b32 v27, 9, v27
  v_bfe_u32 v29, v0, 2, 2
  v_lshl_add_u32 v27, v29, 6, v27
  v_bfe_u32 v29, v0, 4, 1
  v_lshl_add_u32 v27, v29, 5, v27
  v_and_b32 v29, 3, v0
  v_lshl_add_u32 v229, v29, 3, v27
  v_add_u32 v230, 65536, v229
  s_lshl_b32 s62, s14, 10
  v_add_u32 v231, s62, v229
  v_add_u32 v240, s62, v230
  s_lshl_b32 s50, s12, 1
  s_add_u32 s50, s50, s14
  s_add_u32 s53, s12, 44
  s_cmp_eq_u32 s14, 2
  s_cselect_b32 s50, s53, s50
  s_add_u32 s53, s12, 28
  s_cmp_lt_u32 s12, 4
  s_cselect_b32 s53, s53, 58
  s_cmp_eq_u32 s14, 3
  s_cselect_b32 s50, s53, s50
  s_lshr_b32 s53, s16, 15
  s_sub_u32 s53, s53, 24
  s_cmp_ge_u32 s12, 14
  s_cselect_b32 s50, s53, s50
  s_cmp_ge_u32 s50, 58
  s_cselect_b32 s54, 268435456, 0
  s_min_u32 s50, s50, 57
  s_and_b32 s52, s13, 7
  s_lshl_b32 s52, s52, 1
  s_lshr_b32 s53, s13, 3
  s_add_u32 s52, s52, s53
  s_cmp_ge_u32 s50, 28
  s_cbranch_scc1 L_main_tq_4
  s_mov_b32 s96, s84
  s_and_b32 s97, s85, 0xffff
  s_mov_b32 s98, 1835008
  s_mov_b32 s80, s86
  s_and_b32 s81, s87, 0xffff
  s_mul_i32 s51, s50, 37
  s_lshr_b32 s51, s51, 8
  s_mul_i32 s53, s51, 7
  s_sub_u32 s53, s50, s53
  s_mul_i32 s52, s13, 7
  s_add_u32 s52, s52, s53
  s_mov_b32 s86, 3584
  s_mul_i32 s87, s51, 458752
  s_lshl_b32 s53, s52, 5
  s_add_u32 s87, s87, s53
  s_mov_b32 s88, s87
  s_mov_b32 s55, 1
  s_lshl_b32 s84, s52, 15
  s_add_u32 s84, s84, 2220032
  s_lshl_b32 s85, s52, 10
  s_add_u32 s85, s85, 5890048
  s_branch L_main_te_7
L_main_tq_4:
  s_cmp_ge_u32 s50, 40
  s_cbranch_scc1 L_main_to_5
  s_mov_b32 s96, s78
  s_and_b32 s97, s79, 0xffff
  s_mov_b32 s98, 1572864
  s_and_b32 s51, s50, 3
  s_sub_u32 s53, s50, 28
  s_lshr_b32 s53, s53, 2
  s_mul_i32 s52, s13, 3
  s_add_u32 s52, s52, s53
  s_add_u32 s53, s53, 1
  s_cmp_eq_u32 s53, 3
  s_cselect_b32 s53, 0, s53
  s_lshl_b32 s53, s53, 10
  s_mov_b32 s86, 3072
  s_mul_i32 s87, s51, 393216
  s_add_u32 s87, s87, s53
  s_lshl_b32 s53, s13, 6
  s_add_u32 s87, s87, s53
  s_mov_b32 s80, s96
  s_mov_b32 s81, s97
  s_lshl_b32 s88, s86, 4
  s_add_u32 s88, s88, s87
  s_mov_b32 s55, 2
  s_lshl_b32 s84, s52, 15
  s_add_u32 s84, s84, 73728
  s_lshl_b32 s85, s52, 10
  s_add_u32 s85, s85, 1646592
  s_branch L_main_te_7
L_main_to_5:
  s_mov_b32 s96, s88
  s_and_b32 s97, s89, 0xffff
  s_mov_b32 s98, 1835008
  s_sub_u32 s51, s50, 44
  s_mul_i32 s84, s52, 114688
  s_add_u32 s84, s84, 6004736
  s_mov_b32 s86, 1024
  s_lshl_b32 s87, s51, 17
  s_lshl_b32 s53, s52, 6
  s_add_u32 s87, s87, s53
  s_mov_b32 s80, s96
  s_mov_b32 s81, s97
  s_lshl_b32 s88, s86, 4
  s_add_u32 s88, s88, s87
  s_mov_b32 s55, 2
  s_mov_b32 s85, 268435456
  s_add_u32 s84, s84, s54
  s_add_u32 s87, s87, s54
  s_add_u32 s88, s88, s54
L_main_te_7:
  s_mov_b32 s82, s98
  s_mov_b32 s83, 0x20000
  s_lshl_b32 s53, s51, 13
  s_add_u32 s84, s84, s53
  s_and_b32 s51, s51, 3
  s_lshl_b32 s53, s51, 8
  s_add_u32 s85, s85, s53
  v_lshrrev_b32 v27, s55, v0
  v_lshlrev_b32 v28, s55, v27
  v_sub_u32 v28, v0, v28
  v_lshlrev_b32 v28, 4, v28
  v_lshl_add_u32 v247, v27, 6, v28
  v_mul_lo_u32 v27, v27, s86
  v_add_u32 v241, v28, v27
  s_lshl_b32 s53, s14, 13
  v_add_u32 v247, s53, v247
  s_cmp_eq_u32 s55, 1
  s_cselect_b32 s53, 32, 1024
  v_add_u32 v248, s53, v247
  s_lshl_b32 s86, s86, 5
  v_mov_b32 v80, 0
  v_mov_b32 v81, 0
  s_lshr_b32 s50, s14, 1
  s_lshl_b32 s50, s50, 9
  s_and_b32 s51, s14, 1
  s_lshl_b32 s51, s51, 3
  s_add_u32 s50, s50, s51
  s_add_u32 s50, s50, 148480
  v_and_b32 v243, 31, v0
  v_lshlrev_b32 v243, 4, v243
  v_add_u32 v243, s50, v243
  s_lshl_b32 s50, s14, 13
  v_lshrrev_b32 v27, 5, v0
  v_lshlrev_b32 v27, 8, v27
  v_sub_u32 v246, v240, v27
  v_sub_u32 v27, v229, v27
  v_add_u32 v244, s50, v27
  s_getreg_b32 s76, hwreg(HW_REG_XCC_ID, 0, 4)
  s_mul_i32 s77, s76, s76
  s_lshl_b32 s76, s76, 10
  s_add_u32 s76, s76, s77
  s_add_u32 s76, s76, 1048576
  s_mov_b32 s77, 0
  s_add_u32 s51, s37, 0
  v_mov_b32 v250, s51
  s_xor_b32 s51, s51, 2048
  v_writelane_b32 v250, s51, 1
  s_add_u32 s51, s36, 28672
  v_writelane_b32 v250, s51, 2
  v_mov_b32 v251, 16
  s_mov_b32 s51, 16777216
  v_writelane_b32 v251, s51, 2
  v_mov_b32 v36, -1
  v_mov_b32 v37, -1
  v_mov_b32 v38, -1
  v_mov_b32 v39, -1
  s_mov_b32 s51, 14745600
  s_mov_b64 exec, s[56:57]
  buffer_store_dwordx4 v[36:39], v128, s[4:7], 0 offen sc1
  buffer_store_dwordx4 v[36:39], v128, s[4:7], s51 offen sc1
  s_mov_b64 exec, -1
  s_add_u32 s46, s49, 1
  s_and_b32 s46, s46, 3
  s_lshl_b32 s44, s46, 8
  s_add_u32 s44, s44, s16
  s_lshl_b32 s46, s46, 3
  s_add_u32 s46, s46, s14
  s_mul_i32 s45, s46, 49152
  s_lshl_b32 s46, s13, 6
  s_add_u32 s45, s45, s46
  s_lshl_b32 s47, s14, 10
  s_add_u32 s48, s44, 0
  s_add_u32 m0, s43, 8192
  s_nop 0
  buffer_load_dwordx4 v224, s[68:71], s48 offen lds
  s_add_u32 s48, s44, 4096
  s_add_u32 m0, s43, 9216
  s_nop 0
  buffer_load_dwordx4 v225, s[68:71], s48 offen lds
  s_add_u32 s48, s45, 1024
  s_add_u32 m0, s47, 8192
  s_nop 0
  buffer_load_dwordx4 v228, s[72:75], s48 offen lds
  s_add_u32 s48, s44, 8192
  s_add_u32 m0, s43, 10240
  s_nop 0
  buffer_load_dwordx4 v226, s[68:71], s48 offen lds
  s_add_u32 s48, s44, 12288
  s_add_u32 m0, s43, 11264
  s_nop 0
  buffer_load_dwordx4 v227, s[68:71], s48 offen lds
  s_add_u32 s48, s45, 2048
  s_add_u32 m0, s47, 40960
  s_nop 0
  buffer_load_dwordx4 v228, s[72:75], s48 offen lds
  s_add_u32 s48, s44, 16384
  s_add_u32 m0, s43, 12288
  s_nop 0
  buffer_load_dwordx4 v224, s[68:71], s48 offen lds
  s_add_u32 s48, s44, 20480
  s_add_u32 m0, s43, 13312
  s_nop 0
  buffer_load_dwordx4 v225, s[68:71], s48 offen lds
  s_add_u32 s48, s45, 197632
  s_add_u32 m0, s47, 12288
  s_nop 0
  buffer_load_dwordx4 v228, s[72:75], s48 offen lds
  s_add_u32 s48, s44, 24576
  s_add_u32 m0, s43, 14336
  s_nop 0
  buffer_load_dwordx4 v226, s[68:71], s48 offen lds
  s_add_u32 s48, s44, 28672
  s_add_u32 m0, s43, 15360
  s_nop 0
  buffer_load_dwordx4 v227, s[68:71], s48 offen lds
  s_add_u32 s48, s45, 198656
  s_add_u32 m0, s47, 45056
  s_nop 0
  buffer_load_dwordx4 v228, s[72:75], s48 offen lds
  s_waitcnt vmcnt(14)
  s_cmp_lg_u32 s2, 0
  s_cbranch_scc1 L_main_rdy_8
  v_mov_b32 v28, 1
  s_mov_b64 exec, 1
  global_atomic_add v249, v28, s[92:93]
  s_mov_b64 exec, -1
L_main_rdy_8:
  ds_read_b64_tr_b16 v[212:213], v246
  ds_read_b64_tr_b16 v[214:215], v246 offset:512
  ds_read_b128 v[160:163], v232
  ds_read_b128 v[164:167], v233
  ds_read_b128 v[168:171], v234
  ds_read_b128 v[172:175], v235
  ds_read_b128 v[176:179], v236
  ds_read_b128 v[180:183], v237
  ds_read_b128 v[184:187], v238
  ds_read_b128 v[188:191], v239
  ds_read_b64_tr_b16 v[196:197], v231
  ds_read_b64_tr_b16 v[198:199], v231 offset:256
  ds_read_b64_tr_b16 v[200:201], v231 offset:32768
  ds_read_b64_tr_b16 v[202:203], v231 offset:33024
  ds_read_b64_tr_b16 v[204:205], v231 offset:4096
  ds_read_b64_tr_b16 v[206:207], v231 offset:4352
  ds_read_b64_tr_b16 v[208:209], v231 offset:36864
  ds_read_b64_tr_b16 v[210:211], v231 offset:37120
  ds_read_b128 a[0:3], v232
  s_waitcnt lgkmcnt(15)
  v_dot2c_f32_bf16 v80, v160, v8
  v_dot2c_f32_bf16 v81, v160, v160
  v_dot2c_f32_bf16 v80, v161, v8
  v_dot2c_f32_bf16 v81, v161, v161
  v_dot2c_f32_bf16 v80, v162, v8
  v_dot2c_f32_bf16 v81, v162, v162
  v_dot2c_f32_bf16 v80, v163, v8
  v_dot2c_f32_bf16 v81, v163, v163
  ds_read_b128 a[4:7], v233
  s_waitcnt lgkmcnt(15)
  v_dot2c_f32_bf16 v80, v164, v8
  v_dot2c_f32_bf16 v81, v164, v164
  v_dot2c_f32_bf16 v80, v165, v8
  v_dot2c_f32_bf16 v81, v165, v165
  v_dot2c_f32_bf16 v80, v166, v8
  v_dot2c_f32_bf16 v81, v166, v166
  v_dot2c_f32_bf16 v80, v167, v8
  v_dot2c_f32_bf16 v81, v167, v167
  ds_read_b128 a[8:11], v234
  s_waitcnt lgkmcnt(15)
  v_dot2c_f32_bf16 v80, v168, v8
  v_dot2c_f32_bf16 v81, v168, v168
  v_dot2c_f32_bf16 v80, v169, v8
  v_dot2c_f32_bf16 v81, v169, v169
  v_dot2c_f32_bf16 v80, v170, v8
  v_dot2c_f32_bf16 v81, v170, v170
  v_dot2c_f32_bf16 v80, v171, v8
  v_dot2c_f32_bf16 v81, v171, v171
  ds_read_b128 a[12:15], v235
  s_waitcnt lgkmcnt(15)
  v_dot2c_f32_bf16 v80, v172, v8
  v_dot2c_f32_bf16 v81, v172, v172
  v_dot2c_f32_bf16 v80, v173, v8
  v_dot2c_f32_bf16 v81, v173, v173
  v_dot2c_f32_bf16 v80, v174, v8
  v_dot2c_f32_bf16 v81, v174, v174
  v_dot2c_f32_bf16 v80, v175, v8
  v_dot2c_f32_bf16 v81, v175, v175
  ds_read_b128 a[16:19], v236
  s_waitcnt lgkmcnt(15)
  v_dot2c_f32_bf16 v80, v176, v8
  v_dot2c_f32_bf16 v81, v176, v176
  v_dot2c_f32_bf16 v80, v177, v8
  v_dot2c_f32_bf16 v81, v177, v177
  v_dot2c_f32_bf16 v80, v178, v8
  v_dot2c_f32_bf16 v81, v178, v178
  v_dot2c_f32_bf16 v80, v179, v8
  v_dot2c_f32_bf16 v81, v179, v179
  ds_read_b128 a[20:23], v237
  s_waitcnt lgkmcnt(15)
  v_dot2c_f32_bf16 v80, v180, v8
  v_dot2c_f32_bf16 v81, v180, v180
  v_dot2c_f32_bf16 v80, v181, v8
  v_dot2c_f32_bf16 v81, v181, v181
  v_dot2c_f32_bf16 v80, v182, v8
  v_dot2c_f32_bf16 v81, v182, v182
  v_dot2c_f32_bf16 v80, v183, v8
  v_dot2c_f32_bf16 v81, v183, v183
  ds_read_b128 a[24:27], v238
  s_waitcnt lgkmcnt(15)
  v_dot2c_f32_bf16 v80, v184, v8
  v_dot2c_f32_bf16 v81, v184, v184
  v_dot2c_f32_bf16 v80, v185, v8
  v_dot2c_f32_bf16 v81, v185, v185
  v_dot2c_f32_bf16 v80, v186, v8
  v_dot2c_f32_bf16 v81, v186, v186
  v_dot2c_f32_bf16 v80, v187, v8
  v_dot2c_f32_bf16 v81, v187, v187
  ds_read_b128 a[28:31], v239
  s_waitcnt lgkmcnt(15)
  v_dot2c_f32_bf16 v80, v188, v8
  v_dot2c_f32_bf16 v81, v188, v188
  v_dot2c_f32_bf16 v80, v189, v8
  v_dot2c_f32_bf16 v81, v189, v189
  v_dot2c_f32_bf16 v80, v190, v8
  v_dot2c_f32_bf16 v81, v190, v190
  v_dot2c_f32_bf16 v80, v191, v8
  v_dot2c_f32_bf16 v81, v191, v191
  s_waitcnt lgkmcnt(15)
  v_dot2_f32_bf16 v192, v196, v8, 0
  s_nop 2
  v_dot2c_f32_bf16 v192, v197, v8
  s_waitcnt lgkmcnt(14)
  v_dot2c_f32_bf16 v192, v198, v8
  v_dot2c_f32_bf16 v192, v199, v8
  s_waitcnt lgkmcnt(13)
  v_dot2_f32_bf16 v193, v200, v8, 0
  s_nop 2
  v_dot2c_f32_bf16 v193, v201, v8
  s_waitcnt lgkmcnt(12)
  v_dot2c_f32_bf16 v193, v202, v8
  v_dot2c_f32_bf16 v193, v203, v8
  s_waitcnt lgkmcnt(11)
  v_dot2c_f32_bf16 v192, v204, v8
  v_dot2c_f32_bf16 v192, v205, v8
  s_waitcnt lgkmcnt(10)
  v_dot2c_f32_bf16 v192, v206, v8
  v_dot2c_f32_bf16 v192, v207, v8
  s_waitcnt lgkmcnt(9)
  v_dot2c_f32_bf16 v193, v208, v8
  v_dot2c_f32_bf16 v193, v209, v8
  s_waitcnt lgkmcnt(8)
  v_dot2c_f32_bf16 v193, v210, v8
  v_dot2c_f32_bf16 v193, v211, v8
  buffer_store_dwordx4 v[212:215], v1, s[4:7], s3 offen sc1
  s_waitcnt lgkmcnt(0)
  s_barrier
  ds_read_b64_tr_b16 v[96:97], v229
  ds_read_b64_tr_b16 v[98:99], v229 offset:256
  ds_read_b64_tr_b16 v[100:101], v229 offset:32768
  ds_read_b64_tr_b16 v[102:103], v229 offset:33024
  ds_read_b64_tr_b16 v[104:105], v229 offset:1024
  ds_read_b64_tr_b16 v[106:107], v229 offset:1280
  ds_read_b64_tr_b16 v[108:109], v229 offset:33792
  ds_read_b64_tr_b16 v[110:111], v229 offset:34048
  ds_read_b64_tr_b16 v[112:113], v229 offset:2048
  ds_read_b64_tr_b16 v[114:115], v229 offset:2304
  s_waitcnt lgkmcnt(8)
  v_mfma_f32_32x32x16_bf16 v[32:47], a[0:3], v[96:99], 0
  s_add_u32 s46, s49, 2
  s_and_b32 s46, s46, 3
  s_lshl_b32 s44, s46, 8
  s_add_u32 s44, s44, s16
  s_lshl_b32 s46, s46, 3
  s_add_u32 s46, s46, s14
  s_mul_i32 s45, s46, 49152
  s_lshl_b32 s46, s13, 6
  s_add_u32 s45, s45, s46
  s_lshl_b32 s47, s14, 10
  ds_read_b64_tr_b16 v[116:117], v229 offset:34816
  ds_read_b64_tr_b16 v[118:119], v229 offset:35072
  s_waitcnt lgkmcnt(8)
  v_mfma_f32_32x32x16_bf16 v[48:63], a[0:3], v[100:103], 0
  s_add_u32 s48, s44, 0
  s_add_u32 m0, s43, 0
  s_nop 0
  buffer_load_dwordx4 v224, s[68:71], s48 offen lds
  ds_read_b64_tr_b16 v[96:97], v229 offset:3072
  ds_read_b64_tr_b16 v[98:99], v229 offset:3328
  s_waitcnt lgkmcnt(8)
  v_mfma_f32_32x32x16_bf16 v[32:47], a[4:7], v[104:107], v[32:47]
  s_add_u32 s48, s44, 4096
  s_add_u32 m0, s43, 1024
  s_nop 0
  buffer_load_dwordx4 v225, s[68:71], s48 offen lds
  ds_read_b64_tr_b16 v[100:101], v229 offset:35840
  ds_read_b64_tr_b16 v[102:103], v229 offset:36096
  s_waitcnt lgkmcnt(8)
  v_mfma_f32_32x32x16_bf16 v[48:63], a[4:7], v[108:111], v[48:63]
  s_add_u32 s48, s45, 1024
  s_add_u32 m0, s47, 16384
  s_nop 0
  buffer_load_dwordx4 v228, s[72:75], s48 offen lds
  ds_read_b64_tr_b16 v[104:105], v229 offset:4096
  ds_read_b64_tr_b16 v[106:107], v229 offset:4352
  s_waitcnt lgkmcnt(8)
  v_mfma_f32_32x32x16_bf16 v[32:47], a[8:11], v[112:115], v[32:47]
  s_add_u32 s48, s44, 8192
  s_add_u32 m0, s43, 2048
  s_nop 0
  buffer_load_dwordx4 v226, s[68:71], s48 offen lds
  ds_read_b64_tr_b16 v[108:109], v229 offset:36864
  ds_read_b64_tr_b16 v[110:111], v229 offset:37120
  s_waitcnt lgkmcnt(8)
  v_mfma_f32_32x32x16_bf16 v[48:63], a[8:11], v[116:119], v[48:63]
  ds_read_b64_tr_b16 v[112:113], v229 offset:5120
  ds_read_b64_tr_b16 v[114:115], v229 offset:5376
  s_waitcnt lgkmcnt(8)
  v_mfma_f32_32x32x16_bf16 v[32:47], a[12:15], v[96:99], v[32:47]
  s_add_u32 s48, s44, 12288
  s_add_u32 m0, s43, 3072
  s_nop 0
  buffer_load_dwordx4 v227, s[68:71], s48 offen lds
  ds_read_b64_tr_b16 v[116:117], v229 offset:37888
  ds_read_b64_tr_b16 v[118:119], v229 offset:38144
  s_waitcnt lgkmcnt(8)
  v_mfma_f32_32x32x16_bf16 v[48:63], a[12:15], v[100:103], v[48:63]
  s_add_u32 s48, s45, 2048
  s_add_u32 m0, s47, 49152
  s_nop 0
  buffer_load_dwordx4 v228, s[72:75], s48 offen lds
  ds_read_b64_tr_b16 v[96:97], v229 offset:6144
  ds_read_b64_tr_b16 v[98:99], v229 offset:6400
  s_waitcnt lgkmcnt(8)
  v_mfma_f32_32x32x16_bf16 v[32:47], a[16:19], v[104:107], v[32:47]
  s_add_u32 s48, s44, 16384
  s_add_u32 m0, s43, 4096
  s_nop 0
  buffer_load_dwordx4 v224, s[68:71], s48 offen lds
  ds_read_b64_tr_b16 v[100:101], v229 offset:38912
  ds_read_b64_tr_b16 v[102:103], v229 offset:39168
  s_waitcnt lgkmcnt(8)
  v_mfma_f32_32x32x16_bf16 v[48:63], a[16:19], v[108:111], v[48:63]
  s_add_u32 s48, s44, 20480
  s_add_u32 m0, s43, 5120
  s_nop 0
  buffer_load_dwordx4 v225, s[68:71], s48 offen lds
  ds_read_b64_tr_b16 v[104:105], v229 offset:7168
  ds_read_b64_tr_b16 v[106:107], v229 offset:7424
  s_waitcnt lgkmcnt(8)
  v_mfma_f32_32x32x16_bf16 v[32:47], a[20:23], v[112:115], v[32:47]
  ds_read_b64_tr_b16 v[108:109], v229 offset:39936
  ds_read_b64_tr_b16 v[110:111], v229 offset:40192
  s_waitcnt lgkmcnt(8)
  v_mfma_f32_32x32x16_bf16 v[48:63], a[20:23], v[116:119], v[48:63]
  s_add_u32 s48, s45, 197632
  s_add_u32 m0, s47, 20480
  s_nop 0
  buffer_load_dwordx4 v228, s[72:75], s48 offen lds
  s_waitcnt lgkmcnt(6)
  v_mfma_f32_32x32x16_bf16 v[32:47], a[24:27], v[96:99], v[32:47]
  s_add_u32 s48, s44, 24576
  s_add_u32 m0, s43, 6144
  s_nop 0
  buffer_load_dwordx4 v226, s[68:71], s48 offen lds
  s_waitcnt lgkmcnt(4)
  v_mfma_f32_32x32x16_bf16 v[48:63], a[24:27], v[100:103], v[48:63]
  s_add_u32 s48, s44, 28672
  s_add_u32 m0, s43, 7168
  s_nop 0
  buffer_load_dwordx4 v227, s[68:71], s48 offen lds
  s_waitcnt lgkmcnt(2)
  v_mfma_f32_32x32x16_bf16 v[32:47], a[28:31], v[104:107], v[32:47]
  s_add_u32 s48, s45, 198656
  s_add_u32 m0, s47, 53248
  s_nop 0
  buffer_load_dwordx4 v228, s[72:75], s48 offen lds
  s_waitcnt lgkmcnt(0)
  v_mfma_f32_32x32x16_bf16 v[48:63], a[28:31], v[108:111], v[48:63]
  s_waitcnt vmcnt(13)
  s_add_u32 s46, s49, 0
  s_and_b32 s46, s46, 3
  s_lshl_b32 s44, s46, 8
  s_add_u32 s44, s44, s16
  s_lshl_b32 s46, s46, 3
  s_add_u32 s46, s46, s14
  s_mul_i32 s45, s46, 49152
  s_lshl_b32 s46, s13, 6
  s_add_u32 s45, s45, s46
  s_lshl_b32 s47, s14, 10
  ds_read_b128 v[160:163], v232 offset:8192
  ds_read_b128 v[164:167], v233 offset:8192
  ds_read_b128 v[168:171], v234 offset:8192
  ds_read_b128 v[172:175], v235 offset:8192
  ds_read_b128 v[176:179], v236 offset:8192
  ds_read_b128 v[180:183], v237 offset:8192
  ds_read_b128 v[184:187], v238 offset:8192
  ds_read_b128 v[188:191], v239 offset:8192
  ds_read_b64_tr_b16 v[196:197], v231 offset:8192
  ds_read_b64_tr_b16 v[198:199], v231 offset:8448
  ds_read_b64_tr_b16 v[200:201], v231 offset:40960
  ds_read_b64_tr_b16 v[202:203], v231 offset:41216
  ds_read_b64_tr_b16 v[204:205], v231 offset:12288
  ds_read_b64_tr_b16 v[206:207], v231 offset:12544
  ds_read_b64_tr_b16 v[208:209], v231 offset:45056
  ds_read_b64_tr_b16 v[210:211], v231 offset:45312
  ds_read_b128 a[32:35], v232 offset:8192
  s_add_u32 s48, s45, 0
  s_add_u32 m0, s47, 65536
  s_nop 0
  buffer_load_dwordx4 v228, s[72:75], s48 offen lds
  s_waitcnt lgkmcnt(15)
  v_dot2c_f32_bf16 v80, v160, v8
  v_dot2c_f32_bf16 v81, v160, v160
  v_dot2c_f32_bf16 v80, v161, v8
  v_dot2c_f32_bf16 v81, v161, v161
  v_dot2c_f32_bf16 v80, v162, v8
  v_dot2c_f32_bf16 v81, v162, v162
  v_dot2c_f32_bf16 v80, v163, v8
  v_dot2c_f32_bf16 v81, v163, v163
  ds_read_b128 a[36:39], v233 offset:8192
  s_waitcnt lgkmcnt(15)
  v_dot2c_f32_bf16 v80, v164, v8
  v_dot2c_f32_bf16 v81, v164, v164
  v_dot2c_f32_bf16 v80, v165, v8
  v_dot2c_f32_bf16 v81, v165, v165
  v_dot2c_f32_bf16 v80, v166, v8
  v_dot2c_f32_bf16 v81, v166, v166
  v_dot2c_f32_bf16 v80, v167, v8
  v_dot2c_f32_bf16 v81, v167, v167
  s_add_u32 s48, s45, 196608
  s_add_u32 m0, s47, 69632
  s_nop 0
  buffer_load_dwordx4 v228, s[72:75], s48 offen lds
  ds_read_b128 a[40:43], v234 offset:8192
  s_waitcnt lgkmcnt(15)
  v_dot2c_f32_bf16 v80, v168, v8
  v_dot2c_f32_bf16 v81, v168, v168
  v_dot2c_f32_bf16 v80, v169, v8
  v_dot2c_f32_bf16 v81, v169, v169
  v_dot2c_f32_bf16 v80, v170, v8
  v_dot2c_f32_bf16 v81, v170, v170
  v_dot2c_f32_bf16 v80, v171, v8
  v_dot2c_f32_bf16 v81, v171, v171
  ds_read_b128 a[44:47], v235 offset:8192
  s_waitcnt lgkmcnt(15)
  v_dot2c_f32_bf16 v80, v172, v8
  v_dot2c_f32_bf16 v81, v172, v172
  v_dot2c_f32_bf16 v80, v173, v8
  v_dot2c_f32_bf16 v81, v173, v173
  v_dot2c_f32_bf16 v80, v174, v8
  v_dot2c_f32_bf16 v81, v174, v174
  v_dot2c_f32_bf16 v80, v175, v8
  s_add_u32 s46, s49, 1
  s_and_b32 s46, s46, 3
  s_lshl_b32 s44, s46, 8
  s_add_u32 s44, s44, s16
  s_lshl_b32 s46, s46, 3
  s_add_u32 s46, s46, s14
  s_mul_i32 s45, s46, 49152
  s_lshl_b32 s46, s13, 6
  s_add_u32 s45, s45, s46
  s_lshl_b32 s47, s14, 10
  v_dot2c_f32_bf16 v81, v175, v175
  ds_read_b128 a[48:51], v236 offset:8192
  s_waitcnt lgkmcnt(15)
  v_dot2c_f32_bf16 v80, v176, v8
  v_dot2c_f32_bf16 v81, v176, v176
  v_dot2c_f32_bf16 v80, v177, v8
  v_dot2c_f32_bf16 v81, v177, v177
  v_dot2c_f32_bf16 v80, v178, v8
  v_dot2c_f32_bf16 v81, v178, v178
  v_dot2c_f32_bf16 v80, v179, v8
  v_dot2c_f32_bf16 v81, v179, v179
  ds_read_b128 a[52:55], v237 offset:8192
  s_waitcnt lgkmcnt(15)
  v_dot2c_f32_bf16 v80, v180, v8
  v_dot2c_f32_bf16 v81, v180, v180
  v_dot2c_f32_bf16 v80, v181, v8
  v_dot2c_f32_bf16 v81, v181, v181
  v_dot2c_f32_bf16 v80, v182, v8
  v_dot2c_f32_bf16 v81, v182, v182
  s_add_u32 s48, s45, 0
  s_add_u32 m0, s47, 73728
  s_nop 0
  buffer_load_dwordx4 v228, s[72:75], s48 offen lds
  v_dot2c_f32_bf16 v80, v183, v8
  v_dot2c_f32_bf16 v81, v183, v183
  ds_read_b128 a[56:59], v238 offset:8192
  s_waitcnt lgkmcnt(15)
  v_dot2c_f32_bf16 v80, v184, v8
  v_dot2c_f32_bf16 v81, v184, v184
  v_dot2c_f32_bf16 v80, v185, v8
  v_dot2c_f32_bf16 v81, v185, v185
  v_dot2c_f32_bf16 v80, v186, v8
  v_dot2c_f32_bf16 v81, v186, v186
  v_dot2c_f32_bf16 v80, v187, v8
  v_dot2c_f32_bf16 v81, v187, v187
  ds_read_b128 a[60:63], v239 offset:8192
  s_waitcnt lgkmcnt(15)
  v_dot2c_f32_bf16 v80, v188, v8
  v_dot2c_f32_bf16 v81, v188, v188
  v_dot2c_f32_bf16 v80, v189, v8
  v_dot2c_f32_bf16 v81, v189, v189
  v_dot2c_f32_bf16 v80, v190, v8
  s_add_u32 s48, s45, 196608
  s_add_u32 m0, s47, 77824
  s_nop 0
  buffer_load_dwordx4 v228, s[72:75], s48 offen lds
  v_dot2c_f32_bf16 v81, v190, v190
  v_dot2c_f32_bf16 v80, v191, v8
  v_dot2c_f32_bf16 v81, v191, v191
  s_waitcnt lgkmcnt(15)
  v_dot2c_f32_bf16 v192, v196, v8
  v_dot2c_f32_bf16 v192, v197, v8
  s_waitcnt lgkmcnt(14)
  v_dot2c_f32_bf16 v192, v198, v8
  v_dot2c_f32_bf16 v192, v199, v8
  s_waitcnt lgkmcnt(13)
  v_dot2c_f32_bf16 v193, v200, v8
  v_dot2c_f32_bf16 v193, v201, v8
  s_waitcnt lgkmcnt(12)
  v_dot2c_f32_bf16 v193, v202, v8
  v_dot2c_f32_bf16 v193, v203, v8
  s_waitcnt lgkmcnt(11)
  v_dot2c_f32_bf16 v192, v204, v8
  v_dot2c_f32_bf16 v192, v205, v8
  s_waitcnt lgkmcnt(10)
  v_dot2c_f32_bf16 v192, v206, v8
  v_dot2c_f32_bf16 v192, v207, v8
  s_waitcnt lgkmcnt(9)
  v_dot2c_f32_bf16 v193, v208, v8
  v_dot2c_f32_bf16 v193, v209, v8
  s_waitcnt lgkmcnt(8)
  v_dot2c_f32_bf16 v193, v210, v8
  v_dot2c_f32_bf16 v193, v211, v8
  s_waitcnt lgkmcnt(0)
  s_barrier
  ds_read_b64_tr_b16 v[96:97], v229 offset:8192
  ds_read_b64_tr_b16 v[98:99], v229 offset:8448
  ds_read_b64_tr_b16 v[100:101], v229 offset:40960
  ds_read_b64_tr_b16 v[102:103], v229 offset:41216
  ds_read_b64_tr_b16 v[104:105], v229 offset:9216
  ds_read_b64_tr_b16 v[106:107], v229 offset:9472
  ds_read_b64_tr_b16 v[108:109], v229 offset:41984
  ds_read_b64_tr_b16 v[110:111], v229 offset:42240
  ds_read_b64_tr_b16 v[112:113], v229 offset:10240
  ds_read_b64_tr_b16 v[114:115], v229 offset:10496
  s_waitcnt lgkmcnt(8)
  v_mfma_f32_32x32x16_bf16 v[32:47], a[32:35], v[96:99], v[32:47]
  global_load_dword v30, v249, s[92:93] sc1
  ds_read_b64_tr_b16 v[116:117], v229 offset:43008
  ds_read_b64_tr_b16 v[118:119], v229 offset:43264
  s_waitcnt lgkmcnt(8)
  v_mfma_f32_32x32x16_bf16 v[48:63], a[32:35], v[100:103], v[48:63]
  s_add_u32 s46, s49, 3
  s_and_b32 s46, s46, 3
  s_lshl_b32 s44, s46, 8
  s_add_u32 s44, s44, s16
  s_lshl_b32 s46, s46, 3
  s_add_u32 s46, s46, s14
  s_mul_i32 s45, s46, 49152
  s_lshl_b32 s46, s13, 6
  s_add_u32 s45, s45, s46
  s_lshl_b32 s47, s14, 10
  ds_read_b64_tr_b16 v[96:97], v229 offset:11264
  ds_read_b64_tr_b16 v[98:99], v229 offset:11520
  s_waitcnt lgkmcnt(8)
  v_mfma_f32_32x32x16_bf16 v[32:47], a[36:39], v[104:107], v[32:47]
  s_add_u32 s48, s44, 0
  s_add_u32 m0, s43, 8192
  s_nop 0
  buffer_load_dwordx4 v224, s[68:71], s48 offen lds
  ds_read_b64_tr_b16 v[100:101], v229 offset:44032
  ds_read_b64_tr_b16 v[102:103], v229 offset:44288
  s_waitcnt lgkmcnt(8)
  v_mfma_f32_32x32x16_bf16 v[48:63], a[36:39], v[108:111], v[48:63]
  s_add_u32 s48, s44, 4096
  s_add_u32 m0, s43, 9216
  s_nop 0
  buffer_load_dwordx4 v225, s[68:71], s48 offen lds
  ds_read_b64_tr_b16 v[104:105], v229 offset:12288
  ds_read_b64_tr_b16 v[106:107], v229 offset:12544
  s_waitcnt lgkmcnt(8)
  v_mfma_f32_32x32x16_bf16 v[32:47], a[40:43], v[112:115], v[32:47]
  s_add_u32 s48, s45, 1024
  s_add_u32 m0, s47, 24576
  s_nop 0
  buffer_load_dwordx4 v228, s[72:75], s48 offen lds
  ds_read_b64_tr_b16 v[108:109], v229 offset:45056
  ds_read_b64_tr_b16 v[110:111], v229 offset:45312
  s_waitcnt lgkmcnt(8)
  v_mfma_f32_32x32x16_bf16 v[48:63], a[40:43], v[116:119], v[48:63]
  s_add_u32 s48, s44, 8192
  s_add_u32 m0, s43, 10240
  s_nop 0
  buffer_load_dwordx4 v226, s[68:71], s48 offen lds
  ds_read_b64_tr_b16 v[112:113], v229 offset:13312
  ds_read_b64_tr_b16 v[114:115], v229 offset:13568
  s_waitcnt lgkmcnt(8)
  v_mfma_f32_32x32x16_bf16 v[32:47], a[44:47], v[96:99], v[32:47]
  s_add_u32 s48, s44, 12288
  s_add_u32 m0, s43, 11264
  s_nop 0
  buffer_load_dwordx4 v227, s[68:71], s48 offen lds
  ds_read_b64_tr_b16 v[116:117], v229 offset:46080
  ds_read_b64_tr_b16 v[118:119], v229 offset:46336
  s_waitcnt lgkmcnt(8)
  v_mfma_f32_32x32x16_bf16 v[48:63], a[44:47], v[100:103], v[48:63]
  ds_read_b64_tr_b16 v[96:97], v229 offset:14336
  ds_read_b64_tr_b16 v[98:99], v229 offset:14592
  s_waitcnt lgkmcnt(8)
  v_mfma_f32_32x32x16_bf16 v[32:47], a[48:51], v[104:107], v[32:47]
  s_add_u32 s48, s45, 2048
  s_add_u32 m0, s47, 57344
  s_nop 0
  buffer_load_dwordx4 v228, s[72:75], s48 offen lds
  ds_read_b64_tr_b16 v[100:101], v229 offset:47104
  ds_read_b64_tr_b16 v[102:103], v229 offset:47360
  s_waitcnt lgkmcnt(8)
  v_mfma_f32_32x32x16_bf16 v[48:63], a[48:51], v[108:111], v[48:63]
  s_add_u32 s48, s44, 16384
  s_add_u32 m0, s43, 12288
  s_nop 0
  buffer_load_dwordx4 v224, s[68:71], s48 offen lds
  ds_read_b64_tr_b16 v[104:105], v229 offset:15360
  ds_read_b64_tr_b16 v[106:107], v229 offset:15616
  s_waitcnt lgkmcnt(8)
  v_mfma_f32_32x32x16_bf16 v[32:47], a[52:55], v[112:115], v[32:47]
  s_add_u32 s48, s44, 20480
  s_add_u32 m0, s43, 13312
  s_nop 0
  buffer_load_dwordx4 v225, s[68:71], s48 offen lds
  ds_read_b64_tr_b16 v[108:109], v229 offset:48128
  ds_read_b64_tr_b16 v[110:111], v229 offset:48384
  s_waitcnt lgkmcnt(8)
  v_mfma_f32_32x32x16_bf16 v[48:63], a[52:55], v[116:119], v[48:63]
  s_add_u32 s48, s45, 197632
  s_add_u32 m0, s47, 28672
  s_nop 0
  buffer_load_dwordx4 v228, s[72:75], s48 offen lds
  s_waitcnt lgkmcnt(6)
  v_mfma_f32_32x32x16_bf16 v[32:47], a[56:59], v[96:99], v[32:47]
  s_add_u32 s48, s44, 24576
  s_add_u32 m0, s43, 14336
  s_nop 0
  buffer_load_dwordx4 v226, s[68:71], s48 offen lds
  s_waitcnt lgkmcnt(4)
  v_mfma_f32_32x32x16_bf16 v[48:63], a[56:59], v[100:103], v[48:63]
  s_add_u32 s48, s44, 28672
  s_add_u32 m0, s43, 15360
  s_nop 0
  buffer_load_dwordx4 v227, s[68:71], s48 offen lds
  s_waitcnt lgkmcnt(2)
  v_mfma_f32_32x32x16_bf16 v[32:47], a[60:63], v[104:107], v[32:47]
  s_add_u32 s48, s45, 198656
  s_add_u32 m0, s47, 61440
  s_nop 0
  buffer_load_dwordx4 v228, s[72:75], s48 offen lds
  s_waitcnt lgkmcnt(0)
  v_mfma_f32_32x32x16_bf16 v[48:63], a[60:63], v[108:111], v[48:63]
  s_waitcnt vmcnt(17)
  s_add_u32 s46, s49, 2
  s_and_b32 s46, s46, 3
  s_lshl_b32 s44, s46, 8
  s_add_u32 s44, s44, s16
  s_lshl_b32 s46, s46, 3
  s_add_u32 s46, s46, s14
  s_mul_i32 s45, s46, 49152
  s_lshl_b32 s46, s13, 6
  s_add_u32 s45, s45, s46
  s_lshl_b32 s47, s14, 10
  ds_read_b128 v[160:163], v232
  ds_read_b128 v[164:167], v233
  ds_read_b128 v[168:171], v234
  ds_read_b128 v[172:175], v235
  ds_read_b128 v[176:179], v236
  ds_read_b128 v[180:183], v237
  ds_read_b128 v[184:187], v238
  ds_read_b128 v[188:191], v239
  ds_read_b64_tr_b16 v[196:197], v231 offset:16384
  s_add_u32 s48, s45, 0
  s_add_u32 m0, s47, 81920
  s_nop 0
  buffer_load_dwordx4 v228, s[72:75], s48 offen lds
  ds_read_b64_tr_b16 v[198:199], v231 offset:16640
  ds_read_b64_tr_b16 v[200:201], v231 offset:49152
  ds_read_b64_tr_b16 v[202:203], v231 offset:49408
  ds_read_b64_tr_b16 v[204:205], v231 offset:20480
  ds_read_b64_tr_b16 v[206:207], v231 offset:20736
  ds_read_b64_tr_b16 v[208:209], v231 offset:53248
  ds_read_b64_tr_b16 v[210:211], v231 offset:53504
  ds_read_b128 a[64:67], v232
  s_waitcnt lgkmcnt(15)
  v_dot2c_f32_bf16 v80, v160, v8
  s_add_u32 s48, s45, 196608
  s_add_u32 m0, s47, 86016
  s_nop 0
  buffer_load_dwordx4 v228, s[72:75], s48 offen lds
  v_dot2c_f32_bf16 v81, v160, v160
  v_dot2c_f32_bf16 v80, v161, v8
  v_dot2c_f32_bf16 v81, v161, v161
  v_dot2c_f32_bf16 v80, v162, v8
  v_dot2c_f32_bf16 v81, v162, v162
  v_dot2c_f32_bf16 v80, v163, v8
  v_dot2c_f32_bf16 v81, v163, v163
  ds_read_b128 a[68:71], v233
  s_waitcnt lgkmcnt(15)
  v_dot2c_f32_bf16 v80, v164, v8
  s_add_u32 s46, s49, 3
  s_and_b32 s46, s46, 3
  s_lshl_b32 s44, s46, 8
  s_add_u32 s44, s44, s16
  s_lshl_b32 s46, s46, 3
  s_add_u32 s46, s46, s14
  s_mul_i32 s45, s46, 49152
  s_lshl_b32 s46, s13, 6
  s_add_u32 s45, s45, s46
  s_lshl_b32 s47, s14, 10
  v_dot2c_f32_bf16 v81, v164, v164
  v_dot2c_f32_bf16 v80, v165, v8
  v_dot2c_f32_bf16 v81, v165, v165
  v_dot2c_f32_bf16 v80, v166, v8
  v_dot2c_f32_bf16 v81, v166, v166
  v_dot2c_f32_bf16 v80, v167, v8
  v_dot2c_f32_bf16 v81, v167, v167
  ds_read_b128 a[72:75], v234
  s_waitcnt lgkmcnt(15)
  v_dot2c_f32_bf16 v80, v168, v8
  s_add_u32 s48, s45, 0
  s_add_u32 m0, s47, 90112
  s_nop 0
  buffer_load_dwordx4 v228, s[72:75], s48 offen lds
  v_dot2c_f32_bf16 v81, v168, v168
  v_dot2c_f32_bf16 v80, v169, v8
  v_dot2c_f32_bf16 v81, v169, v169
  v_dot2c_f32_bf16 v80, v170, v8
  v_dot2c_f32_bf16 v81, v170, v170
  v_dot2c_f32_bf16 v80, v171, v8
  v_dot2c_f32_bf16 v81, v171, v171
  ds_read_b128 a[76:79], v235
  s_waitcnt lgkmcnt(15)
  v_dot2c_f32_bf16 v80, v172, v8
  s_add_u32 s48, s45, 196608
  s_add_u32 m0, s47, 94208
  s_nop 0
  buffer_load_dwordx4 v228, s[72:75], s48 offen lds
  v_dot2c_f32_bf16 v81, v172, v172
  v_dot2c_f32_bf16 v80, v173, v8
  v_dot2c_f32_bf16 v81, v173, v173
  v_dot2c_f32_bf16 v80, v174, v8
  v_dot2c_f32_bf16 v81, v174, v174
  v_dot2c_f32_bf16 v80, v175, v8
  v_dot2c_f32_bf16 v81, v175, v175
  ds_read_b128 a[80:83], v236
  s_waitcnt lgkmcnt(15)
  v_dot2c_f32_bf16 v80, v176, v8
  v_lshrrev_b32 v29, 5, v0
  v_lshlrev_b32 v29, 3, v29
  v_sub_u32 v242, v26, v29
  v_dot2c_f32_bf16 v81, v176, v176
  v_dot2c_f32_bf16 v80, v177, v8
  v_dot2c_f32_bf16 v81, v177, v177
  v_dot2c_f32_bf16 v80, v178, v8
  v_dot2c_f32_bf16 v81, v178, v178
  v_dot2c_f32_bf16 v80, v179, v8
  v_dot2c_f32_bf16 v81, v179, v179
  ds_read_b128 a[84:87], v237
  s_waitcnt lgkmcnt(15)
  v_dot2c_f32_bf16 v80, v180, v8
  buffer_load_dwordx2 v[136:137], v242, s[68:71], s38 offen
  v_dot2c_f32_bf16 v81, v180, v180
  v_dot2c_f32_bf16 v80, v181, v8
  v_dot2c_f32_bf16 v81, v181, v181
  v_dot2c_f32_bf16 v80, v182, v8
  v_dot2c_f32_bf16 v81, v182, v182
  v_dot2c_f32_bf16 v80, v183, v8
  v_dot2c_f32_bf16 v81, v183, v183
  ds_read_b128 a[88:91], v238
  s_waitcnt lgkmcnt(15)
  v_dot2c_f32_bf16 v80, v184, v8
  buffer_load_dwordx2 v[138:139], v242, s[68:71], s38 offen offset:16
  v_dot2c_f32_bf16 v81, v184, v184
  v_dot2c_f32_bf16 v80, v185, v8
  v_dot2c_f32_bf16 v81, v185, v185
  v_dot2c_f32_bf16 v80, v186, v8
  v_dot2c_f32_bf16 v81, v186, v186
  v_dot2c_f32_bf16 v80, v187, v8
  v_dot2c_f32_bf16 v81, v187, v187
  ds_read_b128 a[92:95], v239
  s_waitcnt lgkmcnt(15)
  v_dot2c_f32_bf16 v80, v188, v8
  buffer_load_dwordx2 v[140:141], v242, s[68:71], s38 offen offset:32
  v_dot2c_f32_bf16 v81, v188, v188
  v_dot2c_f32_bf16 v80, v189, v8
  v_dot2c_f32_bf16 v81, v189, v189
  v_dot2c_f32_bf16 v80, v190, v8
  v_dot2c_f32_bf16 v81, v190, v190
  v_dot2c_f32_bf16 v80, v191, v8
  v_dot2c_f32_bf16 v81, v191, v191
  s_waitcnt lgkmcnt(15)
  v_dot2c_f32_bf16 v192, v196, v8
  v_dot2c_f32_bf16 v192, v197, v8
  buffer_load_dwordx2 v[142:143], v242, s[68:71], s38 offen offset:48
  s_waitcnt lgkmcnt(14)
  v_dot2c_f32_bf16 v192, v198, v8
  v_dot2c_f32_bf16 v192, v199, v8
  s_waitcnt lgkmcnt(13)
  v_dot2c_f32_bf16 v193, v200, v8
  v_dot2c_f32_bf16 v193, v201, v8
  s_waitcnt lgkmcnt(12)
  v_dot2c_f32_bf16 v193, v202, v8
  v_dot2c_f32_bf16 v193, v203, v8
  s_waitcnt lgkmcnt(11)
  v_dot2c_f32_bf16 v192, v204, v8
  v_dot2c_f32_bf16 v192, v205, v8
  s_waitcnt lgkmcnt(10)
  v_dot2c_f32_bf16 v192, v206, v8
  v_dot2c_f32_bf16 v192, v207, v8
  s_waitcnt lgkmcnt(9)
  v_dot2c_f32_bf16 v193, v208, v8
  v_dot2c_f32_bf16 v193, v209, v8
  s_waitcnt lgkmcnt(8)
  v_dot2c_f32_bf16 v193, v210, v8
  v_dot2c_f32_bf16 v193, v211, v8
  s_waitcnt vmcnt(20)
  v_readfirstlane_b32 s64, v30
  s_nop 3
  s_cmp_ge_u32 s64, 4
  s_cbranch_scc1 L_main_adone_9
  s_mov_b32 s63, 0
  s_mov_b64 exec, 1
L_main_poll_10:
  global_load_dword v30, v249, s[92:93] sc1
  s_waitcnt vmcnt(0)
  v_readfirstlane_b32 s64, v30
  s_add_u32 s63, s63, 1
  s_cmp_ge_u32 s63, 4194304
  s_nop 1
  s_cselect_b32 s64, 4, s64
  s_cmp_lt_u32 s64, 4
  s_cbranch_scc1 L_main_poll_10
  s_mov_b64 exec, -1
L_main_adone_9:
  s_waitcnt lgkmcnt(0)
  s_barrier
  s_cmp_lg_u32 s14, 0
  s_cbranch_scc1 L_main_arr_11
  s_add_u32 s62, s37, 0
  v_mov_b32 v30, 1
  s_mov_b64 exec, 1
  buffer_atomic_add v30, off, s[4:7], s62
  s_mov_b64 exec, -1
L_main_arr_11:
  s_cmp_lg_u32 s14, 0
  s_cbranch_scc1 L_main_gx_12
  s_add_u32 s62, s36, 28672
  v_mov_b32 v27, s76
  s_mov_b64 exec, 1
  buffer_atomic_add v27, off, s[4:7], s62
  s_mov_b64 exec, -1
L_main_gx_12:
  ds_read_b64_tr_b16 v[96:97], v229 offset:16384
  ds_read_b64_tr_b16 v[98:99], v229 offset:16640
  ds_read_b64_tr_b16 v[100:101], v229 offset:49152
  ds_read_b64_tr_b16 v[102:103], v229 offset:49408
  ds_read_b64_tr_b16 v[104:105], v229 offset:17408
  ds_read_b64_tr_b16 v[106:107], v229 offset:17664
  ds_read_b64_tr_b16 v[108:109], v229 offset:50176
  ds_read_b64_tr_b16 v[110:111], v229 offset:50432
  ds_read_b64_tr_b16 v[112:113], v229 offset:18432
  ds_read_b64_tr_b16 v[114:115], v229 offset:18688
  s_waitcnt lgkmcnt(8)
  v_mfma_f32_32x32x16_bf16 v[32:47], a[64:67], v[96:99], v[32:47]
  buffer_load_dwordx4 a[128:131], v241, s[96:99], s87 offen
  s_add_u32 s87, s87, s86
  ds_read_b64_tr_b16 v[116:117], v229 offset:51200
  ds_read_b64_tr_b16 v[118:119], v229 offset:51456
  s_waitcnt lgkmcnt(8)
  v_mfma_f32_32x32x16_bf16 v[48:63], a[64:67], v[100:103], v[48:63]
  ds_read_b64_tr_b16 v[96:97], v229 offset:19456
  ds_read_b64_tr_b16 v[98:99], v229 offset:19712
  s_waitcnt lgkmcnt(8)
  v_mfma_f32_32x32x16_bf16 v[32:47], a[68:71], v[104:107], v[32:47]
  buffer_load_dwordx4 a[132:135], v241, s[96:99], s87 offen
  s_add_u32 s87, s87, s86
  ds_read_b64_tr_b16 v[100:101], v229 offset:52224
  ds_read_b64_tr_b16 v[102:103], v229 offset:52480
  s_waitcnt lgkmcnt(8)
  v_mfma_f32_32x32x16_bf16 v[48:63], a[68:71], v[108:111], v[48:63]
  ds_read_b64_tr_b16 v[104:105], v229 offset:20480
  ds_read_b64_tr_b16 v[106:107], v229 offset:20736
  s_waitcnt lgkmcnt(8)
  v_mfma_f32_32x32x16_bf16 v[32:47], a[72:75], v[112:115], v[32:47]
  buffer_load_dwordx4 a[136:139], v241, s[96:99], s87 offen
  s_add_u32 s87, s87, s86
  ds_read_b64_tr_b16 v[108:109], v229 offset:53248
  ds_read_b64_tr_b16 v[110:111], v229 offset:53504
  s_waitcnt lgkmcnt(8)
  v_mfma_f32_32x32x16_bf16 v[48:63], a[72:75], v[116:119], v[48:63]
  ds_read_b64_tr_b16 v[112:113], v229 offset:21504
  ds_read_b64_tr_b16 v[114:115], v229 offset:21760
  s_waitcnt lgkmcnt(8)
  v_mfma_f32_32x32x16_bf16 v[32:47], a[76:79], v[96:99], v[32:47]
  buffer_load_dwordx4 a[140:143], v241, s[96:99], s87 offen
  ds_read_b64_tr_b16 v[116:117], v229 offset:54272
  ds_read_b64_tr_b16 v[118:119], v229 offset:54528
  s_waitcnt lgkmcnt(8)
  v_mfma_f32_32x32x16_bf16 v[48:63], a[76:79], v[100:103], v[48:63]
  ds_read_b64_tr_b16 v[96:97], v229 offset:22528
  ds_read_b64_tr_b16 v[98:99], v229 offset:22784
  s_waitcnt lgkmcnt(8)
  v_mfma_f32_32x32x16_bf16 v[32:47], a[80:83], v[104:107], v[32:47]
  buffer_load_dwordx4 a[144:147], v241, s[80:83], s88 offen
  s_add_u32 s88, s88, s86
  ds_read_b64_tr_b16 v[100:101], v229 offset:55296
  ds_read_b64_tr_b16 v[102:103], v229 offset:55552
  s_waitcnt lgkmcnt(8)
  v_mfma_f32_32x32x16_bf16 v[48:63], a[80:83], v[108:111], v[48:63]
  ds_read_b64_tr_b16 v[104:105], v229 offset:23552
  ds_read_b64_tr_b16 v[106:107], v229 offset:23808
  s_waitcnt lgkmcnt(8)
  v_mfma_f32_32x32x16_bf16 v[32:47], a[84:87], v[112:115], v[32:47]
  buffer_load_dwordx4 a[148:151], v241, s[80:83], s88 offen
  s_add_u32 s88, s88, s86
  ds_read_b64_tr_b16 v[108:109], v229 offset:56320
  ds_read_b64_tr_b16 v[110:111], v229 offset:56576
  s_waitcnt lgkmcnt(8)
  v_mfma_f32_32x32x16_bf16 v[48:63], a[84:87], v[116:119], v[48:63]
  s_waitcnt lgkmcnt(6)
  v_mfma_f32_32x32x16_bf16 v[32:47], a[88:91], v[96:99], v[32:47]
  buffer_load_dwordx4 a[152:155], v241, s[80:83], s88 offen
  s_add_u32 s88, s88, s86
  s_waitcnt lgkmcnt(4)
  v_mfma_f32_32x32x16_bf16 v[48:63], a[88:91], v[100:103], v[48:63]
  s_waitcnt lgkmcnt(2)
  v_mfma_f32_32x32x16_bf16 v[32:47], a[92:95], v[104:107], v[32:47]
  buffer_load_dwordx4 a[156:159], v241, s[80:83], s88 offen
  s_waitcnt lgkmcnt(0)
  v_mfma_f32_32x32x16_bf16 v[48:63], a[92:95], v[108:111], v[48:63]
  s_waitcnt vmcnt(16)
  ds_read_b128 v[160:163], v232 offset:8192
  ds_read_b128 v[164:167], v233 offset:8192
  ds_read_b128 v[168:171], v234 offset:8192
  ds_read_b128 v[172:175], v235 offset:8192
  ds_read_b128 v[176:179], v236 offset:8192
  ds_read_b128 v[180:183], v237 offset:8192
  ds_read_b128 v[184:187], v238 offset:8192
  ds_read_b128 v[188:191], v239 offset:8192
  ds_read_b64_tr_b16 v[196:197], v231 offset:24576
  ds_read_b64_tr_b16 v[198:199], v231 offset:24832
  ds_read_b64_tr_b16 v[200:201], v231 offset:57344
  ds_read_b64_tr_b16 v[202:203], v231 offset:57600
  ds_read_b64_tr_b16 v[204:205], v231 offset:28672
  ds_read_b64_tr_b16 v[206:207], v231 offset:28928
  ds_read_b64_tr_b16 v[208:209], v231 offset:61440
  ds_read_b64_tr_b16 v[210:211], v231 offset:61696
  ds_read_b128 a[96:99], v232 offset:8192
  s_waitcnt lgkmcnt(15)
  v_dot2c_f32_bf16 v80, v160, v8
  v_dot2c_f32_bf16 v81, v160, v160
  v_dot2c_f32_bf16 v80, v161, v8
  v_dot2c_f32_bf16 v81, v161, v161
  v_dot2c_f32_bf16 v80, v162, v8
  v_dot2c_f32_bf16 v81, v162, v162
  v_dot2c_f32_bf16 v80, v163, v8
  v_dot2c_f32_bf16 v81, v163, v163
  ds_read_b128 a[100:103], v233 offset:8192
  s_waitcnt lgkmcnt(15)
  v_dot2c_f32_bf16 v80, v164, v8
  v_dot2c_f32_bf16 v81, v164, v164
  v_dot2c_f32_bf16 v80, v165, v8
  v_dot2c_f32_bf16 v81, v165, v165
  v_dot2c_f32_bf16 v80, v166, v8
  v_dot2c_f32_bf16 v81, v166, v166
  v_dot2c_f32_bf16 v80, v167, v8
  v_dot2c_f32_bf16 v81, v167, v167
  ds_read_b128 a[104:107], v234 offset:8192
  s_waitcnt lgkmcnt(15)
  v_dot2c_f32_bf16 v80, v168, v8
  v_dot2c_f32_bf16 v81, v168, v168
  v_dot2c_f32_bf16 v80, v169, v8
  v_dot2c_f32_bf16 v81, v169, v169
  v_dot2c_f32_bf16 v80, v170, v8
  v_dot2c_f32_bf16 v81, v170, v170
  v_dot2c_f32_bf16 v80, v171, v8
  v_dot2c_f32_bf16 v81, v171, v171
  ds_read_b128 a[108:111], v235 offset:8192
  s_waitcnt lgkmcnt(15)
  v_dot2c_f32_bf16 v80, v172, v8
  v_dot2c_f32_bf16 v81, v172, v172
  v_dot2c_f32_bf16 v80, v173, v8
  v_dot2c_f32_bf16 v81, v173, v173
  v_dot2c_f32_bf16 v80, v174, v8
  v_dot2c_f32_bf16 v81, v174, v174
  v_dot2c_f32_bf16 v80, v175, v8
  v_dot2c_f32_bf16 v81, v175, v175
  ds_read_b128 a[112:115], v236 offset:8192
  s_waitcnt lgkmcnt(15)
  v_dot2c_f32_bf16 v80, v176, v8
  v_dot2c_f32_bf16 v81, v176, v176
  v_dot2c_f32_bf16 v80, v177, v8
  v_dot2c_f32_bf16 v81, v177, v177
  v_dot2c_f32_bf16 v80, v178, v8
  v_dot2c_f32_bf16 v81, v178, v178
  v_dot2c_f32_bf16 v80, v179, v8
  v_dot2c_f32_bf16 v81, v179, v179
  ds_read_b128 a[116:119], v237 offset:8192
  s_waitcnt lgkmcnt(15)
  v_dot2c_f32_bf16 v80, v180, v8
  v_dot2c_f32_bf16 v81, v180, v180
  v_dot2c_f32_bf16 v80, v181, v8
  v_dot2c_f32_bf16 v81, v181, v181
  v_dot2c_f32_bf16 v80, v182, v8
  v_dot2c_f32_bf16 v81, v182, v182
  v_dot2c_f32_bf16 v80, v183, v8
  v_dot2c_f32_bf16 v81, v183, v183
  ds_read_b128 a[120:123], v238 offset:8192
  s_waitcnt lgkmcnt(15)
  v_dot2c_f32_bf16 v80, v184, v8
  v_dot2c_f32_bf16 v81, v184, v184
  v_dot2c_f32_bf16 v80, v185, v8
  v_dot2c_f32_bf16 v81, v185, v185
  v_dot2c_f32_bf16 v80, v186, v8
  v_dot2c_f32_bf16 v81, v186, v186
  v_dot2c_f32_bf16 v80, v187, v8
  v_dot2c_f32_bf16 v81, v187, v187
  ds_read_b128 a[124:127], v239 offset:8192
  s_waitcnt lgkmcnt(15)
  v_dot2c_f32_bf16 v80, v188, v8
  v_dot2c_f32_bf16 v81, v188, v188
  v_dot2c_f32_bf16 v80, v189, v8
  v_dot2c_f32_bf16 v81, v189, v189
  v_dot2c_f32_bf16 v80, v190, v8
  v_dot2c_f32_bf16 v81, v190, v190
  v_dot2c_f32_bf16 v80, v191, v8
  v_dot2c_f32_bf16 v81, v191, v191
  s_waitcnt lgkmcnt(15)
  v_dot2c_f32_bf16 v192, v196, v8
  v_dot2c_f32_bf16 v192, v197, v8
  s_waitcnt lgkmcnt(14)
  v_dot2c_f32_bf16 v192, v198, v8
  v_dot2c_f32_bf16 v192, v199, v8
  s_waitcnt lgkmcnt(13)
  v_dot2c_f32_bf16 v193, v200, v8
  v_dot2c_f32_bf16 v193, v201, v8
  s_waitcnt lgkmcnt(12)
  v_dot2c_f32_bf16 v193, v202, v8
  v_dot2c_f32_bf16 v193, v203, v8
  s_waitcnt lgkmcnt(11)
  v_dot2c_f32_bf16 v192, v204, v8
  v_dot2c_f32_bf16 v192, v205, v8
  s_waitcnt lgkmcnt(10)
  v_dot2c_f32_bf16 v192, v206, v8
  v_dot2c_f32_bf16 v192, v207, v8
  s_waitcnt lgkmcnt(9)
  v_dot2c_f32_bf16 v193, v208, v8
  v_dot2c_f32_bf16 v193, v209, v8
  s_waitcnt lgkmcnt(8)
  v_dot2c_f32_bf16 v193, v210, v8
  v_dot2c_f32_bf16 v193, v211, v8
  v_mov_b32 v196, v192
  s_nop 1
  v_permlane32_swap_b32 v192, v196
  v_add_f32 v192, v192, v196
  v_cvt_pk_bf16_f32 v198, v192, v192
  v_and_b32 v196, 0xffff0000, v198
  v_sub_f32 v196, v192, v196
  v_cvt_pk_bf16_f32 v199, v196, v196
  ds_write_b64 v243, v[198:199]
  v_mov_b32 v196, v193
  s_nop 1
  v_permlane32_swap_b32 v193, v196
  v_add_f32 v193, v193, v196
  v_cvt_pk_bf16_f32 v200, v193, v193
  v_and_b32 v196, 0xffff0000, v200
  v_sub_f32 v196, v193, v196
  v_cvt_pk_bf16_f32 v201, v196, v196
  ds_write_b64 v243, v[200:201] offset:1024
  s_waitcnt lgkmcnt(0)
  s_barrier
  ds_read_b64_tr_b16 v[96:97], v229 offset:24576
  ds_read_b64_tr_b16 v[98:99], v229 offset:24832
  ds_read_b64_tr_b16 v[100:101], v229 offset:57344
  ds_read_b64_tr_b16 v[102:103], v229 offset:57600
  ds_read_b64_tr_b16 v[104:105], v229 offset:25600
  ds_read_b64_tr_b16 v[106:107], v229 offset:25856
  ds_read_b64_tr_b16 v[108:109], v229 offset:58368
  ds_read_b64_tr_b16 v[110:111], v229 offset:58624
  ds_read_b64_tr_b16 v[112:113], v229 offset:26624
  ds_read_b64_tr_b16 v[114:115], v229 offset:26880
  s_waitcnt lgkmcnt(8)
  v_mfma_f32_32x32x16_bf16 v[32:47], a[96:99], v[96:99], v[32:47]
  v_permlane32_swap_b32 v80, v81
  v_add_f32 v80, v80, v81
  v_mov_b32 v81, v80
  ds_read_b64_tr_b16 v[116:117], v229 offset:59392
  ds_read_b64_tr_b16 v[118:119], v229 offset:59648
  s_waitcnt lgkmcnt(8)
  v_mfma_f32_32x32x16_bf16 v[48:63], a[96:99], v[100:103], v[48:63]
  v_permlane32_swap_b32 v80, v81
  v_mul_f32 v80, 0xbb000000, v80
  ds_read_b64_tr_b16 v[96:97], v229 offset:27648
  ds_read_b64_tr_b16 v[98:99], v229 offset:27904
  s_waitcnt lgkmcnt(8)
  v_mfma_f32_32x32x16_bf16 v[32:47], a[100:103], v[104:107], v[32:47]
  v_mul_f32 v81, 0x3b000000, v81
  v_fma_f32 v81, -v80, v80, v81
  v_max_f32 v81, 0, v81
  buffer_load_dword v30, v250, s[4:7], 0 offen sc1
  ds_read_b64_tr_b16 v[100:101], v229 offset:60416
  ds_read_b64_tr_b16 v[102:103], v229 offset:60672
  s_waitcnt lgkmcnt(8)
  v_mfma_f32_32x32x16_bf16 v[48:63], a[100:103], v[108:111], v[48:63]
  v_add_f32 v81, 0x3727c5ac, v81
  v_rsq_f32 v18, v81
  ds_read_b64_tr_b16 v[104:105], v229 offset:28672
  ds_read_b64_tr_b16 v[106:107], v229 offset:28928
  s_waitcnt lgkmcnt(8)
  v_mfma_f32_32x32x16_bf16 v[32:47], a[104:107], v[112:115], v[32:47]
  v_cvt_pk_bf16_f32 v82, v80, v80
  v_and_b32 v82, 0xffff0000, v82
  v_sub_f32 v82, v80, v82
  ds_read_b64_tr_b16 v[108:109], v229 offset:61440
  ds_read_b64_tr_b16 v[110:111], v229 offset:61696
  s_waitcnt lgkmcnt(8)
  v_mfma_f32_32x32x16_bf16 v[48:63], a[104:107], v[116:119], v[48:63]
  v_cvt_pk_bf16_f32 v20, v80, v82
  v_mul_f32 v19, 0x3fb8aa3b, v18
  ds_read_b64_tr_b16 v[112:113], v229 offset:29696
  ds_read_b64_tr_b16 v[114:115], v229 offset:29952
  s_waitcnt lgkmcnt(8)
  v_mfma_f32_32x32x16_bf16 v[32:47], a[108:111], v[96:99], v[32:47]
  v_mov_b32 v21, v20
  v_mov_b32 v22, v20
  v_mov_b32 v23, v20
  ds_read_b64_tr_b16 v[116:117], v229 offset:62464
  ds_read_b64_tr_b16 v[118:119], v229 offset:62720
  s_waitcnt lgkmcnt(8)
  v_mfma_f32_32x32x16_bf16 v[48:63], a[108:111], v[100:103], v[48:63]
  v_cndmask_b32 v27, v18, v19, s[60:61]
  ds_write_b32 v24, v27
  ds_read_b64_tr_b16 v[96:97], v229 offset:30720
  ds_read_b64_tr_b16 v[98:99], v229 offset:30976
  s_waitcnt lgkmcnt(9)
  v_mfma_f32_32x32x16_bf16 v[32:47], a[112:115], v[104:107], v[32:47]
  ds_read_b128 v[144:147], v25 offset:0
  ds_read_b128 v[148:151], v25 offset:32
  ds_read_b128 v[152:155], v25 offset:64
  ds_read_b64_tr_b16 v[100:101], v229 offset:63488
  ds_read_b64_tr_b16 v[102:103], v229 offset:63744
  s_waitcnt lgkmcnt(12)
  v_mfma_f32_32x32x16_bf16 v[48:63], a[112:115], v[108:111], v[48:63]
  ds_read_b128 v[156:159], v25 offset:96
  ds_read_b128 v[80:83], v25 offset:128
  ds_read_b64_tr_b16 v[104:105], v229 offset:31744
  ds_read_b64_tr_b16 v[106:107], v229 offset:32000
  s_waitcnt lgkmcnt(14)
  v_mfma_f32_32x32x16_bf16 v[32:47], a[116:119], v[112:115], v[32:47]
  ds_read_b128 v[84:87], v25 offset:160
  ds_read_b128 v[88:91], v25 offset:192
  ds_read_b128 v[92:95], v25 offset:224
  ds_read_b64_tr_b16 v[108:109], v229 offset:64512
  ds_read_b64_tr_b16 v[110:111], v229 offset:64768
  s_waitcnt lgkmcnt(15)
  v_mfma_f32_32x32x16_bf16 v[48:63], a[116:119], v[116:119], v[48:63]
  ds_read_b128 v[212:215], v3 offset:17408
  ds_read_b128 v[216:219], v3 offset:18432
  s_waitcnt lgkmcnt(15)
  v_mfma_f32_32x32x16_bf16 v[32:47], a[120:123], v[96:99], v[32:47]
  s_waitcnt lgkmcnt(11)
  v_mfma_f32_32x32x16_bf16 v[48:63], a[120:123], v[100:103], v[48:63]
  s_waitcnt lgkmcnt(7)
  v_mfma_f32_32x32x16_bf16 v[32:47], a[124:127], v[104:107], v[32:47]
  s_waitcnt lgkmcnt(2)
  v_mfma_f32_32x32x16_bf16 v[48:63], a[124:127], v[108:111], v[48:63]
  s_waitcnt lgkmcnt(0)
  v_mfma_f32_32x32x16_bf16 v[48:63], v[20:23], v[216:219], v[48:63]
  v_mfma_f32_32x32x16_bf16 v[32:47], v[20:23], v[212:215], v[32:47]
  s_waitcnt vmcnt(13)
  s_nop 9
  v_mul_f32 v48, v48, v80
  v_mul_f32 v49, v49, v81
  v_cvt_pk_bf16_f32 v176, v48, v49
  v_mul_f32 v50, v50, v82
  v_mul_f32 v51, v51, v83
  v_cvt_pk_bf16_f32 v177, v50, v51
  v_mul_f32 v52, v52, v84
  v_mul_f32 v53, v53, v85
  v_cvt_pk_bf16_f32 v178, v52, v53
  v_mul_f32 v54, v54, v86
  v_mul_f32 v55, v55, v87
  v_cvt_pk_bf16_f32 v179, v54, v55
  v_mul_f32 v56, v56, v88
  v_mul_f32 v57, v57, v89
  v_cvt_pk_bf16_f32 v180, v56, v57
  v_mul_f32 v58, v58, v90
  v_mul_f32 v59, v59, v91
  v_cvt_pk_bf16_f32 v181, v58, v59
  v_mul_f32 v60, v60, v92
  v_mul_f32 v61, v61, v93
  v_cvt_pk_bf16_f32 v182, v60, v61
  v_mul_f32 v62, v62, v94
  v_mul_f32 v63, v63, v95
  v_cvt_pk_bf16_f32 v183, v62, v63
  v_mov_b32 v80, v8
  v_mov_b32 v81, v8
  v_mov_b32 v82, v8
  v_mov_b32 v83, v8
  v_fma_f32 v32, v32, v144, s39
  v_exp_f32 v27, v32 clamp
  v_max_f32 v32, s39, v32
  v_fma_f32 v33, v33, v145, s39
  v_fma_f32 v32, v32, s40, v27
  v_exp_f32 v28, v33 clamp
  v_max_f32 v33, s39, v33
  v_fma_f32 v34, v34, v146, s39
  v_fma_f32 v33, v33, s40, v28
  v_cvt_pk_bf16_f32 v120, v32, v33
  v_exp_f32 v27, v34 clamp
  v_max_f32 v34, s39, v34
  v_fma_f32 v35, v35, v147, s39
  v_fma_f32 v34, v34, s40, v27
  v_exp_f32 v28, v35 clamp
  v_max_f32 v35, s39, v35
  v_fma_f32 v36, v36, v148, s39
  v_fma_f32 v35, v35, s40, v28
  v_cvt_pk_bf16_f32 v121, v34, v35
  v_exp_f32 v27, v36 clamp
  v_max_f32 v36, s39, v36
  v_fma_f32 v37, v37, v149, s39
  v_fma_f32 v36, v36, s40, v27
  v_exp_f32 v28, v37 clamp
  v_max_f32 v37, s39, v37
  v_fma_f32 v38, v38, v150, s39
  v_fma_f32 v37, v37, s40, v28
  v_cvt_pk_bf16_f32 v122, v36, v37
  v_exp_f32 v27, v38 clamp
  v_max_f32 v38, s39, v38
  v_fma_f32 v39, v39, v151, s39
  v_fma_f32 v38, v38, s40, v27
  v_exp_f32 v28, v39 clamp
  v_max_f32 v39, s39, v39
  v_fma_f32 v40, v40, v152, s39
  v_fma_f32 v39, v39, s40, v28
  v_cvt_pk_bf16_f32 v123, v38, v39
  v_exp_f32 v27, v40 clamp
  v_max_f32 v40, s39, v40
  v_fma_f32 v41, v41, v153, s39
  v_fma_f32 v40, v40, s40, v27
  v_exp_f32 v28, v41 clamp
  v_max_f32 v41, s39, v41
  v_fma_f32 v42, v42, v154, s39
  v_fma_f32 v41, v41, s40, v28
  v_cvt_pk_bf16_f32 v124, v40, v41
  v_exp_f32 v27, v42 clamp
  v_max_f32 v42, s39, v42
  v_fma_f32 v43, v43, v155, s39
  v_fma_f32 v42, v42, s40, v27
  v_exp_f32 v28, v43 clamp
  v_max_f32 v43, s39, v43
  v_fma_f32 v44, v44, v156, s39
  v_fma_f32 v43, v43, s40, v28
  v_cvt_pk_bf16_f32 v125, v42, v43
  v_exp_f32 v27, v44 clamp
  v_max_f32 v44, s39, v44
  v_fma_f32 v45, v45, v157, s39
  v_fma_f32 v44, v44, s40, v27
  v_exp_f32 v28, v45 clamp
  v_max_f32 v45, s39, v45
  v_fma_f32 v46, v46, v158, s39
  v_fma_f32 v45, v45, s40, v28
  v_cvt_pk_bf16_f32 v126, v44, v45
  v_exp_f32 v27, v46 clamp
  v_max_f32 v46, s39, v46
  v_fma_f32 v47, v47, v159, s39
  v_fma_f32 v46, v46, s40, v27
  v_exp_f32 v28, v47 clamp
  v_max_f32 v47, s39, v47
  v_fma_f32 v47, v47, s40, v28
  v_cvt_pk_bf16_f32 v127, v46, v47
  v_mfma_f32_32x32x16_bf16 v[32:47], v[120:123], v[176:179], 0
  s_nop 0
  v_mfma_f32_32x32x16_bf16 v[32:47], v[124:127], v[180:183], v[32:47]
  v_mfma_f32_32x32x16_bf16 v[48:63], v[120:123], v[80:83], 0
  v_mfma_f32_32x32x16_bf16 v[48:63], v[124:127], v[80:83], v[48:63]
  s_nop 9
  v_cndmask_b32 v32, v32, v40, s[58:59]
  v_cndmask_b32 v33, v33, v41, s[58:59]
  v_cndmask_b32 v34, v34, v42, s[58:59]
  v_cndmask_b32 v35, v35, v43, s[58:59]
  v_cndmask_b32 v36, v36, v44, s[58:59]
  v_cndmask_b32 v37, v37, v45, s[58:59]
  v_cndmask_b32 v38, v38, v46, s[58:59]
  v_cndmask_b32 v39, v39, v47, s[58:59]
  ds_write_b128 v5, v[32:35]
  ds_write_b128 v5, v[36:39] offset:16
  v_cndmask_b32 v48, v48, v56, s[58:59]
  v_cndmask_b32 v49, v49, v57, s[58:59]
  v_cndmask_b32 v50, v50, v58, s[58:59]
  v_cndmask_b32 v51, v51, v59, s[58:59]
  v_cndmask_b32 v52, v52, v60, s[58:59]
  v_cndmask_b32 v53, v53, v61, s[58:59]
  v_cndmask_b32 v54, v54, v62, s[58:59]
  v_cndmask_b32 v55, v55, v63, s[58:59]
  ds_write_b128 v6, v[48:51]
  ds_write_b128 v6, v[52:55] offset:16
  s_waitcnt lgkmcnt(0)
  s_barrier
  ds_read_b128 v[32:35], v7
  ds_read_b128 v[36:39], v7 offset:2304
  ds_read_b128 v[40:43], v7 offset:4608
  ds_read_b128 v[44:47], v7 offset:6912
  s_waitcnt lgkmcnt(2)
  v_pk_add_f32 v[32:33], v[32:33], v[36:37]
  s_waitcnt lgkmcnt(0)
  v_pk_add_f32 v[40:41], v[40:41], v[44:45]
  v_pk_add_f32 v[34:35], v[34:35], v[38:39]
  v_pk_add_f32 v[42:43], v[42:43], v[46:47]
  v_pk_add_f32 v[32:33], v[32:33], v[40:41]
  v_pk_add_f32 v[34:35], v[34:35], v[42:43]
  s_mov_b64 exec, s[56:57]
  buffer_store_dwordx4 v[32:35], v128, s[4:7], s34 offen sc1
  s_mov_b64 exec, -1
  ds_read_b64_tr_b16 v[160:161], v240
  ds_read_b64_tr_b16 v[162:163], v240 offset:256
  ds_read_b64_tr_b16 v[164:165], v240 offset:4096
  ds_read_b64_tr_b16 v[166:167], v240 offset:4352
  ds_read_b64_tr_b16 v[168:169], v240 offset:8192
  ds_read_b64_tr_b16 v[170:171], v240 offset:8448
  ds_read_b64_tr_b16 v[172:173], v240 offset:12288
  ds_read_b64_tr_b16 v[174:175], v240 offset:12544
  ds_read_b64_tr_b16 v[176:177], v240 offset:16384
  ds_read_b64_tr_b16 v[178:179], v240 offset:16640
  ds_read_b64_tr_b16 v[180:181], v240 offset:20480
  ds_read_b64_tr_b16 v[182:183], v240 offset:20736
  ds_read_b64_tr_b16 v[184:185], v240 offset:24576
  ds_read_b64_tr_b16 v[186:187], v240 offset:24832
  ds_read_b64_tr_b16 v[188:189], v240 offset:28672
  ds_read_b64_tr_b16 v[190:191], v240 offset:28928
  s_waitcnt vmcnt(9)
  ds_write_b128 v247, a[128:131] offset:0
  s_waitcnt vmcnt(8)
  ds_write_b128 v247, a[132:135] offset:2048
  s_waitcnt vmcnt(7)
  ds_write_b128 v247, a[136:139] offset:4096
  s_waitcnt vmcnt(6)
  ds_write_b128 v247, a[140:143] offset:6144
  s_waitcnt vmcnt(5)
  ds_write_b128 v248, a[144:147] offset:0
  s_waitcnt vmcnt(4)
  ds_write_b128 v248, a[148:151] offset:2048
  s_waitcnt vmcnt(3)
  ds_write_b128 v248, a[152:155] offset:4096
  s_waitcnt vmcnt(2)
  ds_write_b128 v248, a[156:159] offset:6144
  s_waitcnt lgkmcnt(15)
  v_dot2_f32_bf16 v194, v160, v8, 0
  s_nop 2
  v_dot2c_f32_bf16 v194, v161, v8
  s_waitcnt lgkmcnt(15)
  v_dot2c_f32_bf16 v194, v162, v8
  v_dot2c_f32_bf16 v194, v163, v8
  s_waitcnt lgkmcnt(15)
  v_dot2c_f32_bf16 v194, v164, v8
  v_dot2c_f32_bf16 v194, v165, v8
  s_waitcnt lgkmcnt(15)
  v_dot2c_f32_bf16 v194, v166, v8
  v_dot2c_f32_bf16 v194, v167, v8
  s_waitcnt lgkmcnt(15)
  v_dot2c_f32_bf16 v194, v168, v8
  v_dot2c_f32_bf16 v194, v169, v8
  s_waitcnt lgkmcnt(15)
  v_dot2c_f32_bf16 v194, v170, v8
  v_dot2c_f32_bf16 v194, v171, v8
  s_waitcnt lgkmcnt(15)
  v_dot2c_f32_bf16 v194, v172, v8
  v_dot2c_f32_bf16 v194, v173, v8
  s_waitcnt lgkmcnt(15)
  v_dot2c_f32_bf16 v194, v174, v8
  v_dot2c_f32_bf16 v194, v175, v8
  s_waitcnt lgkmcnt(15)
  v_dot2c_f32_bf16 v194, v176, v8
  v_dot2c_f32_bf16 v194, v177, v8
  s_waitcnt lgkmcnt(14)
  v_dot2c_f32_bf16 v194, v178, v8
  v_dot2c_f32_bf16 v194, v179, v8
  s_waitcnt lgkmcnt(13)
  v_dot2c_f32_bf16 v194, v180, v8
  v_dot2c_f32_bf16 v194, v181, v8
  s_waitcnt lgkmcnt(12)
  v_dot2c_f32_bf16 v194, v182, v8
  v_dot2c_f32_bf16 v194, v183, v8
  s_waitcnt lgkmcnt(11)
  v_dot2c_f32_bf16 v194, v184, v8
  v_dot2c_f32_bf16 v194, v185, v8
  s_waitcnt lgkmcnt(10)
  v_dot2c_f32_bf16 v194, v186, v8
  v_dot2c_f32_bf16 v194, v187, v8
  s_waitcnt lgkmcnt(9)
  v_dot2c_f32_bf16 v194, v188, v8
  v_dot2c_f32_bf16 v194, v189, v8
  s_waitcnt lgkmcnt(8)
  v_dot2c_f32_bf16 v194, v190, v8
  v_dot2c_f32_bf16 v194, v191, v8
  s_nop 2
  v_mov_b32 v196, v194
  s_nop 1
  v_permlane32_swap_b32 v194, v196
  v_add_f32 v194, v194, v196
  v_cvt_pk_bf16_f32 v198, v194, v194
  v_and_b32 v196, 0xffff0000, v198
  v_sub_f32 v196, v194, v196
  v_cvt_pk_bf16_f32 v199, v196, v196
  ds_write_b64 v243, v[198:199] offset:2048
  ds_read_b64_tr_b16 v[160:161], v244 offset:0
  ds_read_b64_tr_b16 v[162:163], v244 offset:512
  ds_read_b64_tr_b16 v[164:165], v244 offset:1024
  ds_read_b64_tr_b16 v[166:167], v244 offset:1536
  ds_read_b64_tr_b16 v[168:169], v244 offset:2048
  ds_read_b64_tr_b16 v[170:171], v244 offset:2560
  ds_read_b64_tr_b16 v[172:173], v244 offset:3072
  ds_read_b64_tr_b16 v[174:175], v244 offset:3584
  ds_read_b64_tr_b16 v[176:177], v244 offset:4096
  ds_read_b64_tr_b16 v[178:179], v244 offset:4608
  ds_read_b64_tr_b16 v[180:181], v244 offset:5120
  ds_read_b64_tr_b16 v[182:183], v244 offset:5632
  ds_read_b64_tr_b16 v[184:185], v244 offset:6144
  ds_read_b64_tr_b16 v[186:187], v244 offset:6656
  ds_read_b64_tr_b16 v[188:189], v244 offset:7168
  ds_read_b64_tr_b16 v[190:191], v244 offset:7680
  s_mov_b32 s63, 0
  s_waitcnt vmcnt(1)
  v_cmp_gt_u32 s[64:65], v251, v30
  s_nop 3
  s_cmp_lg_u64 s[64:65], 0
  s_cbranch_scc1 L_main_pkl_13
L_main_pkd_14:
  v_readlane_b32 s64, v30, 2
  s_lshl_b32 s76, s76, 4
  s_nop 2
  s_cmp_eq_u32 s76, s64
  s_cselect_b32 s76, 1, 0
  s_waitcnt lgkmcnt(15)
  v_dot2_f32_bf16 v196, v160, v8, 0
  s_nop 2
  v_dot2c_f32_bf16 v196, v161, v8
  s_waitcnt lgkmcnt(14)
  v_dot2c_f32_bf16 v196, v162, v8
  v_dot2c_f32_bf16 v196, v163, v8
  s_waitcnt lgkmcnt(13)
  v_dot2c_f32_bf16 v196, v164, v8
  v_dot2c_f32_bf16 v196, v165, v8
  s_waitcnt lgkmcnt(12)
  v_dot2c_f32_bf16 v196, v166, v8
  v_dot2c_f32_bf16 v196, v167, v8
  s_waitcnt lgkmcnt(11)
  v_dot2c_f32_bf16 v196, v168, v8
  v_dot2c_f32_bf16 v196, v169, v8
  s_waitcnt lgkmcnt(10)
  v_dot2c_f32_bf16 v196, v170, v8
  v_dot2c_f32_bf16 v196, v171, v8
  s_waitcnt lgkmcnt(9)
  v_dot2c_f32_bf16 v196, v172, v8
  v_dot2c_f32_bf16 v196, v173, v8
  s_waitcnt lgkmcnt(8)
  v_dot2c_f32_bf16 v196, v174, v8
  v_dot2c_f32_bf16 v196, v175, v8
  s_waitcnt lgkmcnt(7)
  v_dot2c_f32_bf16 v196, v176, v8
  v_dot2c_f32_bf16 v196, v177, v8
  s_waitcnt lgkmcnt(6)
  v_dot2c_f32_bf16 v196, v178, v8
  v_dot2c_f32_bf16 v196, v179, v8
  s_waitcnt lgkmcnt(5)
  v_dot2c_f32_bf16 v196, v180, v8
  v_dot2c_f32_bf16 v196, v181, v8
  s_waitcnt lgkmcnt(4)
  v_dot2c_f32_bf16 v196, v182, v8
  v_dot2c_f32_bf16 v196, v183, v8
  s_waitcnt lgkmcnt(3)
  v_dot2c_f32_bf16 v196, v184, v8
  v_dot2c_f32_bf16 v196, v185, v8
  s_waitcnt lgkmcnt(2)
  v_dot2c_f32_bf16 v196, v186, v8
  v_dot2c_f32_bf16 v196, v187, v8
  s_waitcnt lgkmcnt(1)
  v_dot2c_f32_bf16 v196, v188, v8
  v_dot2c_f32_bf16 v196, v189, v8
  s_waitcnt lgkmcnt(0)
  v_dot2c_f32_bf16 v196, v190, v8
  v_dot2c_f32_bf16 v196, v191, v8
  s_nop 2
  v_mov_b32 v197, v196
  s_nop 1
  v_permlane32_swap_b32 v196, v197
  v_add_f32 v196, v196, v197
  v_cvt_pk_bf16_f32 v198, v196, v196
  v_and_b32 v197, 0xffff0000, v198
  v_sub_f32 v197, v196, v197
  v_cvt_pk_bf16_f32 v199, v197, v197
  v_and_b32 v27, 31, v0
  v_lshlrev_b32 v29, 3, v27
  s_add_u32 s51, s84, 4096
  ds_read_b64_tr_b16 v[96:97], v230
  ds_read_b64_tr_b16 v[98:99], v230 offset:256
  ds_read_b64_tr_b16 v[100:101], v230 offset:1024
  ds_read_b64_tr_b16 v[102:103], v230 offset:1280
  ds_read_b64_tr_b16 v[104:105], v230 offset:2048
  ds_read_b64_tr_b16 v[106:107], v230 offset:2304
  ds_read_b64_tr_b16 v[108:109], v230 offset:3072
  ds_read_b64_tr_b16 v[110:111], v230 offset:3328
  ds_read_b64_tr_b16 v[112:113], v230 offset:4096
  ds_read_b64_tr_b16 v[114:115], v230 offset:4352
  s_waitcnt lgkmcnt(8)
  v_mfma_f32_32x32x16_bf16 v[64:79], v[96:99], a[0:3], 0
  buffer_store_dwordx4 v[160:163], v1, s[4:7], s84 offen offset:0 sc1
  ds_read_b64_tr_b16 v[116:117], v230 offset:5120
  ds_read_b64_tr_b16 v[118:119], v230 offset:5376
  s_waitcnt lgkmcnt(8)
  v_mfma_f32_32x32x16_bf16 v[64:79], v[100:103], a[4:7], v[64:79]
  ds_read_b64_tr_b16 v[96:97], v230 offset:6144
  ds_read_b64_tr_b16 v[98:99], v230 offset:6400
  s_waitcnt lgkmcnt(8)
  v_mfma_f32_32x32x16_bf16 v[64:79], v[104:107], a[8:11], v[64:79]
  buffer_store_dwordx4 v[164:167], v1, s[4:7], s84 offen offset:1024 sc1
  ds_read_b64_tr_b16 v[100:101], v230 offset:7168
  ds_read_b64_tr_b16 v[102:103], v230 offset:7424
  s_waitcnt lgkmcnt(8)
  v_mfma_f32_32x32x16_bf16 v[64:79], v[108:111], a[12:15], v[64:79]
  ds_read_b64_tr_b16 v[104:105], v230 offset:8192
  ds_read_b64_tr_b16 v[106:107], v230 offset:8448
  s_waitcnt lgkmcnt(8)
  v_mfma_f32_32x32x16_bf16 v[64:79], v[112:115], a[16:19], v[64:79]
  buffer_store_dwordx4 v[168:171], v1, s[4:7], s84 offen offset:2048 sc1
  ds_read_b64_tr_b16 v[108:109], v230 offset:9216
  ds_read_b64_tr_b16 v[110:111], v230 offset:9472
  s_waitcnt lgkmcnt(8)
  v_mfma_f32_32x32x16_bf16 v[64:79], v[116:119], a[20:23], v[64:79]
  ds_read_b64_tr_b16 v[112:113], v230 offset:10240
  ds_read_b64_tr_b16 v[114:115], v230 offset:10496
  s_waitcnt lgkmcnt(8)
  v_mfma_f32_32x32x16_bf16 v[64:79], v[96:99], a[24:27], v[64:79]
  buffer_store_dwordx4 v[172:175], v1, s[4:7], s84 offen offset:3072 sc1
  ds_read_b64_tr_b16 v[116:117], v230 offset:11264
  ds_read_b64_tr_b16 v[118:119], v230 offset:11520
  s_waitcnt lgkmcnt(8)
  v_mfma_f32_32x32x16_bf16 v[64:79], v[100:103], a[28:31], v[64:79]
  ds_read_b64_tr_b16 v[96:97], v230 offset:12288
  ds_read_b64_tr_b16 v[98:99], v230 offset:12544
  s_waitcnt lgkmcnt(8)
  v_mfma_f32_32x32x16_bf16 v[64:79], v[104:107], a[32:35], v[64:79]
  buffer_store_dwordx4 v[176:179], v1, s[4:7], s51 offen offset:0 sc1
  ds_read_b64_tr_b16 v[100:101], v230 offset:13312
  ds_read_b64_tr_b16 v[102:103], v230 offset:13568
  s_waitcnt lgkmcnt(8)
  v_mfma_f32_32x32x16_bf16 v[64:79], v[108:111], a[36:39], v[64:79]
  ds_read_b64_tr_b16 v[104:105], v230 offset:14336
  ds_read_b64_tr_b16 v[106:107], v230 offset:14592
  s_waitcnt lgkmcnt(8)
  v_mfma_f32_32x32x16_bf16 v[64:79], v[112:115], a[40:43], v[64:79]
  buffer_store_dwordx4 v[180:183], v1, s[4:7], s51 offen offset:1024 sc1
  ds_read_b64_tr_b16 v[108:109], v230 offset:15360
  ds_read_b64_tr_b16 v[110:111], v230 offset:15616
  s_waitcnt lgkmcnt(8)
  v_mfma_f32_32x32x16_bf16 v[64:79], v[116:119], a[44:47], v[64:79]
  ds_read_b64_tr_b16 v[112:113], v230 offset:16384
  ds_read_b64_tr_b16 v[114:115], v230 offset:16640
  s_waitcnt lgkmcnt(8)
  v_mfma_f32_32x32x16_bf16 v[64:79], v[96:99], a[48:51], v[64:79]
  buffer_store_dwordx4 v[184:187], v1, s[4:7], s51 offen offset:2048 sc1
  ds_read_b64_tr_b16 v[116:117], v230 offset:17408
  ds_read_b64_tr_b16 v[118:119], v230 offset:17664
  s_waitcnt lgkmcnt(8)
  v_mfma_f32_32x32x16_bf16 v[64:79], v[100:103], a[52:55], v[64:79]
  ds_read_b64_tr_b16 v[96:97], v230 offset:18432
  ds_read_b64_tr_b16 v[98:99], v230 offset:18688
  s_waitcnt lgkmcnt(8)
  v_mfma_f32_32x32x16_bf16 v[64:79], v[104:107], a[56:59], v[64:79]
  buffer_store_dwordx4 v[188:191], v1, s[4:7], s51 offen offset:3072 sc1
  ds_read_b64_tr_b16 v[100:101], v230 offset:19456
  ds_read_b64_tr_b16 v[102:103], v230 offset:19712
  s_waitcnt lgkmcnt(8)
  v_mfma_f32_32x32x16_bf16 v[64:79], v[108:111], a[60:63], v[64:79]
  ds_read_b64_tr_b16 v[104:105], v230 offset:20480
  ds_read_b64_tr_b16 v[106:107], v230 offset:20736
  s_waitcnt lgkmcnt(8)
  v_mfma_f32_32x32x16_bf16 v[64:79], v[112:115], a[64:67], v[64:79]
  s_mov_b64 exec, s[60:61]
  buffer_store_dwordx2 v[198:199], v29, s[4:7], s85 offen sc1
  s_mov_b64 exec, -1
  ds_read_b64_tr_b16 v[108:109], v230 offset:21504
  ds_read_b64_tr_b16 v[110:111], v230 offset:21760
  s_waitcnt lgkmcnt(8)
  v_mfma_f32_32x32x16_bf16 v[64:79], v[116:119], a[68:71], v[64:79]
  ds_read_b64_tr_b16 v[112:113], v230 offset:22528
  ds_read_b64_tr_b16 v[114:115], v230 offset:22784
  s_waitcnt lgkmcnt(8)
  v_mfma_f32_32x32x16_bf16 v[64:79], v[96:99], a[72:75], v[64:79]
  ds_read_b64_tr_b16 v[116:117], v230 offset:23552
  ds_read_b64_tr_b16 v[118:119], v230 offset:23808
  s_waitcnt lgkmcnt(8)
  v_mfma_f32_32x32x16_bf16 v[64:79], v[100:103], a[76:79], v[64:79]
  ds_read_b64_tr_b16 v[96:97], v230 offset:24576
  ds_read_b64_tr_b16 v[98:99], v230 offset:24832
  s_waitcnt lgkmcnt(8)
  v_mfma_f32_32x32x16_bf16 v[64:79], v[104:107], a[80:83], v[64:79]
  ds_read_b64_tr_b16 v[100:101], v230 offset:25600
  ds_read_b64_tr_b16 v[102:103], v230 offset:25856
  s_waitcnt lgkmcnt(8)
  v_mfma_f32_32x32x16_bf16 v[64:79], v[108:111], a[84:87], v[64:79]
  ds_read_b64_tr_b16 v[104:105], v230 offset:26624
  ds_read_b64_tr_b16 v[106:107], v230 offset:26880
  s_waitcnt lgkmcnt(8)
  v_mfma_f32_32x32x16_bf16 v[64:79], v[112:115], a[88:91], v[64:79]
  ds_read_b64_tr_b16 v[108:109], v230 offset:27648
  ds_read_b64_tr_b16 v[110:111], v230 offset:27904
  s_waitcnt lgkmcnt(8)
  v_mfma_f32_32x32x16_bf16 v[64:79], v[116:119], a[92:95], v[64:79]
  ds_read_b64_tr_b16 v[112:113], v230 offset:28672
  ds_read_b64_tr_b16 v[114:115], v230 offset:28928
  s_barrier
  ds_read_b128 v[212:215], v3 offset:19456
  s_waitcnt lgkmcnt(9)
  v_mfma_f32_32x32x16_bf16 v[64:79], v[96:99], a[96:99], v[64:79]
  ds_read_b64_tr_b16 v[116:117], v230 offset:29696
  ds_read_b64_tr_b16 v[118:119], v230 offset:29952
  s_waitcnt lgkmcnt(9)
  v_mfma_f32_32x32x16_bf16 v[64:79], v[100:103], a[100:103], v[64:79]
  ds_read_b64_tr_b16 v[96:97], v230 offset:30720
  ds_read_b64_tr_b16 v[98:99], v230 offset:30976
  s_waitcnt lgkmcnt(9)
  v_mfma_f32_32x32x16_bf16 v[64:79], v[104:107], a[104:107], v[64:79]
  ds_read_b64_tr_b16 v[100:101], v230 offset:31744
  ds_read_b64_tr_b16 v[102:103], v230 offset:32000
  s_waitcnt lgkmcnt(9)
  v_mfma_f32_32x32x16_bf16 v[64:79], v[108:111], a[108:111], v[64:79]
  s_waitcnt lgkmcnt(7)
  v_mfma_f32_32x32x16_bf16 v[64:79], v[112:115], a[112:115], v[64:79]
  s_waitcnt lgkmcnt(4)
  v_mfma_f32_32x32x16_bf16 v[64:79], v[116:119], a[116:119], v[64:79]
  s_waitcnt lgkmcnt(2)
  v_mfma_f32_32x32x16_bf16 v[64:79], v[96:99], a[120:123], v[64:79]
  s_waitcnt lgkmcnt(0)
  v_mfma_f32_32x32x16_bf16 v[64:79], v[100:103], a[124:127], v[64:79]
  v_mfma_f32_32x32x16_bf16 v[64:79], v[212:215], v[20:23], v[64:79]
  s_add_u32 s51, s37, 24576
  v_mov_b32 v250, s51
  v_mov_b32 v251, 16
L_body:
  buffer_load_dwordx2 v[80:81], v130, s[4:7], s41 offen sc1
  s_nop 7
  v_fma_f32 v64, v64, v19, s39
  v_exp_f32 v27, v64 clamp
  v_max_f32 v64, s39, v64
  v_fma_f32 v65, v65, v19, s39
  v_fma_f32 v64, v64, s40, v27
  v_exp_f32 v28, v65 clamp
  v_max_f32 v65, s39, v65
  v_fma_f32 v66, v66, v19, s39
  s_add_u32 s44, s35, 38797312
  buffer_load_dwordx4 v[32:35], v129, s[4:7], s44 offen sc1
  v_fma_f32 v65, v65, s40, v28
  v_cvt_pk_bf16_f32 v120, v64, v65
  v_exp_f32 v27, v66 clamp
  v_max_f32 v66, s39, v66
  v_fma_f32 v67, v67, v19, s39
  v_fma_f32 v66, v66, s40, v27
  v_exp_f32 v28, v67 clamp
  v_max_f32 v67, s39, v67
  s_add_u32 s44, s35, 38801408
  buffer_load_dwordx4 v[36:39], v129, s[4:7], s44 offen sc1
  v_fma_f32 v68, v68, v19, s39
  v_fma_f32 v67, v67, s40, v28
  v_cvt_pk_bf16_f32 v121, v66, v67
  v_exp_f32 v27, v68 clamp
  v_max_f32 v68, s39, v68
  v_fma_f32 v69, v69, v19, s39
  v_fma_f32 v68, v68, s40, v27
  v_exp_f32 v28, v69 clamp
  s_add_u32 s44, s35, 38805504
  buffer_load_dwordx4 v[40:43], v129, s[4:7], s44 offen sc1
  v_max_f32 v69, s39, v69
  v_fma_f32 v70, v70, v19, s39
  v_fma_f32 v69, v69, s40, v28
  v_cvt_pk_bf16_f32 v122, v68, v69
  v_exp_f32 v27, v70 clamp
  v_max_f32 v70, s39, v70
  v_fma_f32 v71, v71, v19, s39
  v_fma_f32 v70, v70, s40, v27
  s_add_u32 s44, s35, 38809600
  buffer_load_dwordx4 v[44:47], v129, s[4:7], s44 offen sc1
  v_exp_f32 v28, v71 clamp
  v_max_f32 v71, s39, v71
  v_fma_f32 v72, v72, v19, s39
  v_fma_f32 v71, v71, s40, v28
  v_cvt_pk_bf16_f32 v123, v70, v71
  v_exp_f32 v27, v72 clamp
  v_max_f32 v72, s39, v72
  v_fma_f32 v73, v73, v19, s39
  s_add_u32 s44, s35, 38813696
  buffer_load_dwordx4 v[48:51], v129, s[4:7], s44 offen sc1
  v_fma_f32 v72, v72, s40, v27
  v_exp_f32 v28, v73 clamp
  v_max_f32 v73, s39, v73
  v_fma_f32 v74, v74, v19, s39
  v_fma_f32 v73, v73, s40, v28
  v_cvt_pk_bf16_f32 v124, v72, v73
  v_exp_f32 v27, v74 clamp
  v_max_f32 v74, s39, v74
  s_add_u32 s44, s35, 38817792
  buffer_load_dwordx4 v[52:55], v129, s[4:7], s44 offen sc1
  v_fma_f32 v75, v75, v19, s39
  v_fma_f32 v74, v74, s40, v27
  v_exp_f32 v28, v75 clamp
  v_max_f32 v75, s39, v75
  v_fma_f32 v76, v76, v19, s39
  v_fma_f32 v75, v75, s40, v28
  v_cvt_pk_bf16_f32 v125, v74, v75
  v_exp_f32 v27, v76 clamp
  s_add_u32 s44, s35, 38821888
  buffer_load_dwordx4 v[56:59], v129, s[4:7], s44 offen sc1
  v_max_f32 v76, s39, v76
  v_fma_f32 v77, v77, v19, s39
  v_fma_f32 v76, v76, s40, v27
  v_exp_f32 v28, v77 clamp
  v_max_f32 v77, s39, v77
  v_fma_f32 v78, v78, v19, s39
  v_fma_f32 v77, v77, s40, v28
  v_cvt_pk_bf16_f32 v126, v76, v77
  s_add_u32 s44, s35, 38825984
  buffer_load_dwordx4 v[60:63], v129, s[4:7], s44 offen sc1
  v_exp_f32 v27, v78 clamp
  v_max_f32 v78, s39, v78
  v_fma_f32 v79, v79, v19, s39
  v_fma_f32 v78, v78, s40, v27
  v_exp_f32 v28, v79 clamp
  v_max_f32 v79, s39, v79
  v_fma_f32 v79, v79, s40, v28
  v_cvt_pk_bf16_f32 v127, v78, v79
  s_add_u32 s45, s26, 1695744
  buffer_load_dwordx4 a[0:3], v1, s[4:7], s45 offen sc1
  buffer_load_dwordx4 a[4:7], v1, s[4:7], s45 offen offset:1024 sc1
  buffer_load_dwordx4 a[8:11], v1, s[4:7], s45 offen offset:2048 sc1
  buffer_load_dwordx4 a[12:15], v1, s[4:7], s45 offen offset:3072 sc1
  s_add_u32 s45, s26, 1699840
  buffer_load_dwordx4 a[16:19], v1, s[4:7], s45 offen sc1
  buffer_load_dwordx4 a[20:23], v1, s[4:7], s45 offen offset:1024 sc1
  buffer_load_dwordx4 a[24:27], v1, s[4:7], s45 offen offset:2048 sc1
  buffer_load_dwordx4 a[28:31], v1, s[4:7], s45 offen offset:3072 sc1
  s_mov_b32 s63, 0
L_main_gsum_15:
  s_waitcnt vmcnt(16)
  v_permlane32_swap_b32 v80, v81
  v_add_f32 v80, v80, v81
  s_nop 1
  v_add_f32_dpp v80, v80, v80 row_ror:4 row_mask:0xf bank_mask:0xf
  s_nop 1
  v_add_f32_dpp v80, v80, v80 row_ror:8 row_mask:0xf bank_mask:0xf
  v_mov_b32 v81, v80
  s_nop 1
  v_permlane16_swap_b32 v80, v81
  v_add_f32 v80, v80, v81
  s_waitcnt vmcnt(14)
  v_pk_add_f32 v[32:33], v[32:33], v[36:37]
  v_pk_add_f32 v[34:35], v[34:35], v[38:39]
  s_waitcnt vmcnt(13)
  v_pk_add_f32 v[32:33], v[32:33], v[40:41]
  v_pk_add_f32 v[34:35], v[34:35], v[42:43]
  s_waitcnt vmcnt(12)
  v_pk_add_f32 v[32:33], v[32:33], v[44:45]
  v_pk_add_f32 v[34:35], v[34:35], v[46:47]
  s_waitcnt vmcnt(11)
  v_pk_add_f32 v[32:33], v[32:33], v[48:49]
  v_pk_add_f32 v[34:35], v[34:35], v[50:51]
  s_waitcnt vmcnt(10)
  v_pk_add_f32 v[32:33], v[32:33], v[52:53]
  v_pk_add_f32 v[34:35], v[34:35], v[54:55]
  s_waitcnt vmcnt(9)
  v_pk_add_f32 v[32:33], v[32:33], v[56:57]
  v_pk_add_f32 v[34:35], v[34:35], v[58:59]
  s_waitcnt vmcnt(8)
  v_pk_add_f32 v[32:33], v[32:33], v[60:61]
  v_pk_add_f32 v[34:35], v[34:35], v[62:63]
  s_nop 1
  v_permlane32_swap_b32 v32, v34
  v_permlane32_swap_b32 v33, v35
  v_pk_add_f32 v[32:33], v[32:33], v[34:35]
  v_add_f32 v27, v32, v80
  v_cmp_u_f32 s[64:65], v27, v33
  v_cvt_pk_bf16_f32 v80, v80, v80
  v_cvt_pk_bf16_f32 v32, v32, v33
  s_nop 1
  s_cmp_lg_u64 s[64:65], 0
  s_cbranch_scc1 L_main_gretry_16
L_main_gok_17:
  ds_write_b16 v131, v80
  ds_write_b32 v16, v32
  s_add_u32 s45, s27, 1695744
  buffer_load_dwordx4 a[32:35], v1, s[4:7], s45 offen sc1
  buffer_load_dwordx4 a[36:39], v1, s[4:7], s45 offen offset:1024 sc1
  buffer_load_dwordx4 a[40:43], v1, s[4:7], s45 offen offset:2048 sc1
  buffer_load_dwordx4 a[44:47], v1, s[4:7], s45 offen offset:3072 sc1
  s_add_u32 s45, s27, 1699840
  buffer_load_dwordx4 a[48:51], v1, s[4:7], s45 offen sc1
  buffer_load_dwordx4 a[52:55], v1, s[4:7], s45 offen offset:1024 sc1
  buffer_load_dwordx4 a[56:59], v1, s[4:7], s45 offen offset:2048 sc1
  buffer_load_dwordx4 a[60:63], v1, s[4:7], s45 offen offset:3072 sc1
  s_waitcnt lgkmcnt(0)
  s_barrier
  s_cbranch_vccnz L_main_pka_18
  s_cmp_lg_u32 s14, 0
  s_cbranch_scc1 L_main_pka_18
  v_mov_b32 v30, 1
  s_mov_b64 exec, 1
  buffer_atomic_add v30, v250, s[4:7], 0 offen
  s_mov_b64 exec, -1
L_main_pka_18:
  ds_read_b128 v[96:99], v17
  ds_read_b128 v[100:103], v17 offset:544
  s_waitcnt lgkmcnt(1)
  v_mfma_f32_32x32x16_bf16 v[48:63], v[96:99], v[120:123], 0
  s_waitcnt lgkmcnt(0)
  v_mfma_f32_32x32x16_bf16 v[64:79], v[100:103], v[124:127], 0
  s_add_u32 s44, s22, 29360128
  v_lshlrev_b32 v32, 16, v136
  v_and_b32 v33, 0xffff0000, v136
  v_lshlrev_b32 v34, 16, v137
  v_and_b32 v35, 0xffff0000, v137
  v_lshlrev_b32 v36, 16, v138
  v_and_b32 v37, 0xffff0000, v138
  v_lshlrev_b32 v38, 16, v139
  v_and_b32 v39, 0xffff0000, v139
  v_lshlrev_b32 v40, 16, v140
  v_and_b32 v41, 0xffff0000, v140
  v_lshlrev_b32 v42, 16, v141
  v_and_b32 v43, 0xffff0000, v141
  v_lshlrev_b32 v44, 16, v142
  v_and_b32 v45, 0xffff0000, v142
  v_lshlrev_b32 v46, 16, v143
  v_and_b32 v47, 0xffff0000, v143
  v_add_f32 v27, 0x358637bd, v56
  v_rcp_f32 v27, v27
  s_nop 0
  v_mul_f32 v48, v48, v27
  v_mul_f32 v49, v49, v27
  v_cvt_pk_bf16_f32 v56, v48, v49
  v_mul_f32 v50, v50, v27
  v_mul_f32 v51, v51, v27
  v_cvt_pk_bf16_f32 v57, v50, v51
  v_mul_f32 v52, v52, v27
  v_mul_f32 v53, v53, v27
  v_cvt_pk_bf16_f32 v58, v52, v53
  v_mul_f32 v54, v54, v27
  v_mul_f32 v55, v55, v27
  v_cvt_pk_bf16_f32 v59, v54, v55
  buffer_store_dwordx4 v[56:59], v1, s[4:7], s44 offen sc1
  v_add_f32 v27, 0x358637bd, v72
  v_rcp_f32 v27, v27
  s_nop 0
  v_mul_f32 v64, v64, v27
  v_mul_f32 v65, v65, v27
  v_cvt_pk_bf16_f32 v72, v64, v65
  v_mul_f32 v66, v66, v27
  v_mul_f32 v67, v67, v27
  v_cvt_pk_bf16_f32 v73, v66, v67
  v_mul_f32 v68, v68, v27
  v_mul_f32 v69, v69, v27
  v_cvt_pk_bf16_f32 v74, v68, v69
  v_mul_f32 v70, v70, v27
  v_mul_f32 v71, v71, v27
  v_cvt_pk_bf16_f32 v75, v70, v71
  buffer_store_dwordx4 v[72:75], v1, s[4:7], s44 offen offset:1024 sc1
  s_add_u32 s64, s77, 1
  v_mov_b32 v29, s64
  s_waitcnt vmcnt(0)
  s_mov_b64 exec, 1
  s_cmp_eq_u32 s76, 0
  s_cbranch_scc1 L_main_pslow_19
  buffer_store_dword v29, off, s[4:7], s100
L_main_pdone_20:
  s_mov_b64 exec, -1
  buffer_load_dword v30, v9, s[4:7], 0 offen sc1
  s_add_u32 s62, s77, 1
  s_mov_b32 s63, 0
  s_waitcnt vmcnt(0)
  v_cmp_gt_u32 s[64:65], s62, v30
  s_nop 3
  s_cmp_lg_u64 s[64:65], 0
  s_cbranch_scc1 L_main_floop_21
L_main_finv_23:
L_main_fdone_22:
  s_add_u32 s44, s24, 29360128
  buffer_load_dwordx4 a[64:67], v1, s[4:7], s44 offen sc1
  s_add_u32 s45, s25, 29360128
  buffer_load_dwordx4 a[68:71], v1, s[4:7], s45 offen sc1
  buffer_load_dwordx4 a[72:75], v1, s[4:7], s44 offen offset:1024 sc1
  buffer_load_dwordx4 a[76:79], v1, s[4:7], s45 offen offset:1024 sc1
  buffer_load_dwordx4 a[80:83], v1, s[4:7], s44 offen offset:2048 sc1
  buffer_load_dwordx4 a[84:87], v1, s[4:7], s45 offen offset:2048 sc1
  buffer_load_dwordx4 a[88:91], v1, s[4:7], s44 offen offset:3072 sc1
  buffer_load_dwordx4 a[92:95], v1, s[4:7], s45 offen offset:3072 sc1
  s_add_u32 s44, s24, 29364224
  buffer_load_dwordx4 a[96:99], v1, s[4:7], s44 offen sc1
  s_add_u32 s45, s25, 29364224
  buffer_load_dwordx4 a[100:103], v1, s[4:7], s45 offen sc1
  buffer_load_dwordx4 a[104:107], v1, s[4:7], s44 offen offset:1024 sc1
  buffer_load_dwordx4 a[108:111], v1, s[4:7], s45 offen offset:1024 sc1
  buffer_load_dwordx4 a[112:115], v1, s[4:7], s44 offen offset:2048 sc1
  buffer_load_dwordx4 a[116:119], v1, s[4:7], s45 offen offset:2048 sc1
  buffer_load_dwordx4 a[120:123], v1, s[4:7], s44 offen offset:3072 sc1
  buffer_load_dwordx4 a[124:127], v1, s[4:7], s45 offen offset:3072 sc1
  s_waitcnt vmcnt(15)
  v_mfma_f32_32x32x16_bf16 v[32:47], a[0:3], a[64:67], v[32:47]
  v_mfma_f32_32x32x16_bf16 v[48:63], a[32:35], a[64:67], 0
  s_waitcnt vmcnt(14)
  v_mfma_f32_32x32x16_bf16 v[64:79], a[0:3], a[68:71], 0
  v_mfma_f32_32x32x16_bf16 v[80:95], a[32:35], a[68:71], 0
  s_waitcnt vmcnt(13)
  v_mfma_f32_32x32x16_bf16 v[32:47], a[4:7], a[72:75], v[32:47]
  v_mfma_f32_32x32x16_bf16 v[48:63], a[36:39], a[72:75], v[48:63]
  s_waitcnt vmcnt(12)
  v_mfma_f32_32x32x16_bf16 v[64:79], a[4:7], a[76:79], v[64:79]
  v_mfma_f32_32x32x16_bf16 v[80:95], a[36:39], a[76:79], v[80:95]
  s_waitcnt vmcnt(11)
  v_mfma_f32_32x32x16_bf16 v[32:47], a[8:11], a[80:83], v[32:47]
  s_cbranch_vccnz L_main_skip_26
  buffer_load_dword v30, v250, s[4:7], 0 offen sc1
L_main_skip_26:
  v_mfma_f32_32x32x16_bf16 v[48:63], a[40:43], a[80:83], v[48:63]
  s_waitcnt vmcnt(11)
  s_cbranch_vccz L_main_w_87
  s_waitcnt vmcnt(10)
L_main_w_87:
  v_mfma_f32_32x32x16_bf16 v[64:79], a[8:11], a[84:87], v[64:79]
  v_mfma_f32_32x32x16_bf16 v[80:95], a[40:43], a[84:87], v[80:95]
  s_waitcnt vmcnt(10)
  s_cbranch_vccz L_main_w_88
  s_waitcnt vmcnt(9)
L_main_w_88:
  v_mfma_f32_32x32x16_bf16 v[32:47], a[12:15], a[88:91], v[32:47]
  v_mfma_f32_32x32x16_bf16 v[48:63], a[44:47], a[88:91], v[48:63]
  s_waitcnt vmcnt(9)
  s_cbranch_vccz L_main_w_89
  s_waitcnt vmcnt(8)
L_main_w_89:
  v_mfma_f32_32x32x16_bf16 v[64:79], a[12:15], a[92:95], v[64:79]
  v_mfma_f32_32x32x16_bf16 v[80:95], a[44:47], a[92:95], v[80:95]
  s_waitcnt vmcnt(8)
  s_cbranch_vccz L_main_w_90
  s_waitcnt vmcnt(7)
L_main_w_90:
  v_mfma_f32_32x32x16_bf16 v[32:47], a[16:19], a[96:99], v[32:47]
  v_mfma_f32_32x32x16_bf16 v[48:63], a[48:51], a[96:99], v[48:63]
  s_waitcnt vmcnt(7)
  s_cbranch_vccz L_main_w_91
  s_waitcnt vmcnt(6)
L_main_w_91:
  v_mfma_f32_32x32x16_bf16 v[64:79], a[16:19], a[100:103], v[64:79]
  v_mfma_f32_32x32x16_bf16 v[80:95], a[48:51], a[100:103], v[80:95]
  s_waitcnt vmcnt(6)
  s_cbranch_vccz L_main_w_92
  s_waitcnt vmcnt(5)
L_main_w_92:
  v_mfma_f32_32x32x16_bf16 v[32:47], a[20:23], a[104:107], v[32:47]
  v_mfma_f32_32x32x16_bf16 v[48:63], a[52:55], a[104:107], v[48:63]
  s_waitcnt vmcnt(5)
  s_cbranch_vccz L_main_w_93
  s_waitcnt vmcnt(4)
L_main_w_93:
  v_mfma_f32_32x32x16_bf16 v[64:79], a[20:23], a[108:111], v[64:79]
  v_mfma_f32_32x32x16_bf16 v[80:95], a[52:55], a[108:111], v[80:95]
  s_waitcnt vmcnt(3)
  s_cbranch_vccz L_main_w_94
  s_waitcnt vmcnt(2)
L_main_w_94:
  v_mfma_f32_32x32x16_bf16 v[80:95], a[56:59], a[116:119], v[80:95]
  s_waitcnt vmcnt(1)
  s_cbranch_vccz L_main_w_95
  s_waitcnt vmcnt(0)
L_main_w_95:
  v_mfma_f32_32x32x16_bf16 v[80:95], a[60:63], a[124:127], v[80:95]
  v_mfma_f32_32x32x16_bf16 v[64:79], a[24:27], a[116:119], v[64:79]
  v_mfma_f32_32x32x16_bf16 v[64:79], a[28:31], a[124:127], v[64:79]
  v_mfma_f32_32x32x16_bf16 v[48:63], a[56:59], a[112:115], v[48:63]
  s_nop 8
  ds_write_b128 v14, v[80:83] offset:0
  ds_write_b128 v14, v[84:87] offset:1024
  v_mfma_f32_32x32x16_bf16 v[48:63], a[60:63], a[120:123], v[48:63]
  ds_write_b128 v14, v[88:91] offset:2048
  ds_write_b128 v14, v[92:95] offset:3072
  v_mfma_f32_32x32x16_bf16 v[32:47], a[24:27], a[112:115], v[32:47]
  ds_write_b128 v13, v[64:67] offset:0
  ds_write_b128 v13, v[68:71] offset:1024
  v_mfma_f32_32x32x16_bf16 v[32:47], a[28:31], a[120:123], v[32:47]
  ds_write_b128 v13, v[72:75] offset:2048
  ds_write_b128 v13, v[76:79] offset:3072
  s_nop 3
  ds_write_b128 v12, v[48:51] offset:0
  ds_write_b128 v12, v[52:55] offset:1024
  ds_write_b128 v12, v[56:59] offset:2048
  ds_write_b128 v12, v[60:63] offset:3072
  s_cbranch_vccz L_main_skip_25
  s_add_u32 s49, s19, 2301952
  s_add_u32 m0, s15, 81920
  s_nop 0
  buffer_load_dwordx4 v1, s[4:7], s49 offen sc1 lds
  buffer_load_dwordx4 v1, s[4:7], s49 offen offset:1024 sc1 lds
  buffer_load_dwordx4 v1, s[4:7], s49 offen offset:2048 sc1 lds
  buffer_load_dwordx4 v1, s[4:7], s49 offen offset:3072 sc1 lds
L_main_skip_25:
  s_cbranch_vccz L_main_pkg_27
L_main_pkf_29:
  s_cbranch_vccnz L_main_skip_31
  s_add_u32 s49, s19, 2220032
  s_add_u32 m0, s15, 0
  s_nop 0
  buffer_load_dwordx4 v1, s[4:7], s49 offen sc1 lds
  buffer_load_dwordx4 v1, s[4:7], s49 offen offset:1024 sc1 lds
L_main_skip_31:
  s_cbranch_vccnz L_main_skip_32
  buffer_load_dwordx4 v1, s[4:7], s49 offen offset:2048 sc1 lds
  buffer_load_dwordx4 v1, s[4:7], s49 offen offset:3072 sc1 lds
L_main_skip_32:
  s_cbranch_vccnz L_main_skip_33
  s_add_u32 s49, s19, 2252800
  s_add_u32 m0, s15, 16384
  s_nop 0
  buffer_load_dwordx4 v1, s[4:7], s49 offen sc1 lds
  buffer_load_dwordx4 v1, s[4:7], s49 offen offset:1024 sc1 lds
L_main_skip_33:
  s_cbranch_vccnz L_main_skip_34
  buffer_load_dwordx4 v1, s[4:7], s49 offen offset:2048 sc1 lds
  buffer_load_dwordx4 v1, s[4:7], s49 offen offset:3072 sc1 lds
L_main_skip_34:
  s_cbranch_vccnz L_main_skip_35
  s_add_u32 s49, s19, 2285568
  s_add_u32 m0, s15, 32768
  s_nop 0
  buffer_load_dwordx4 v1, s[4:7], s49 offen sc1 lds
  buffer_load_dwordx4 v1, s[4:7], s49 offen offset:1024 sc1 lds
L_main_skip_35:
  s_cbranch_vccnz L_main_skip_36
  buffer_load_dwordx4 v1, s[4:7], s49 offen offset:2048 sc1 lds
  buffer_load_dwordx4 v1, s[4:7], s49 offen offset:3072 sc1 lds
L_main_skip_36:
  s_waitcnt lgkmcnt(0)
  s_barrier
  ds_read_b128 v[48:51], v15 offset:0
  ds_read_b128 v[52:55], v15 offset:1024
  ds_read_b128 v[56:59], v15 offset:2048
  ds_read_b128 v[60:63], v15 offset:3072
  ds_read_b128 v[64:67], v15 offset:4096
  ds_read_b128 v[68:71], v15 offset:5120
  ds_read_b128 v[72:75], v15 offset:6144
  ds_read_b128 v[76:79], v15 offset:7168
  ds_read_b128 v[80:83], v15 offset:8192
  ds_read_b128 v[84:87], v15 offset:9216
  ds_read_b128 v[88:91], v15 offset:10240
  ds_read_b128 v[92:95], v15 offset:11264
  s_waitcnt lgkmcnt(11)
  v_pk_add_f32 v[32:33], v[32:33], v[48:49]
  v_pk_add_f32 v[34:35], v[34:35], v[50:51]
  s_waitcnt lgkmcnt(10)
  v_pk_add_f32 v[36:37], v[36:37], v[52:53]
  v_pk_add_f32 v[38:39], v[38:39], v[54:55]
  s_waitcnt lgkmcnt(9)
  v_pk_add_f32 v[40:41], v[40:41], v[56:57]
  v_pk_add_f32 v[42:43], v[42:43], v[58:59]
  s_waitcnt lgkmcnt(8)
  v_pk_add_f32 v[44:45], v[44:45], v[60:61]
  v_pk_add_f32 v[46:47], v[46:47], v[62:63]
  s_waitcnt lgkmcnt(7)
  v_pk_add_f32 v[32:33], v[32:33], v[64:65]
  v_pk_add_f32 v[34:35], v[34:35], v[66:67]
  s_waitcnt lgkmcnt(6)
  v_pk_add_f32 v[36:37], v[36:37], v[68:69]
  v_pk_add_f32 v[38:39], v[38:39], v[70:71]
  s_waitcnt lgkmcnt(5)
  v_pk_add_f32 v[40:41], v[40:41], v[72:73]
  v_pk_add_f32 v[42:43], v[42:43], v[74:75]
  s_waitcnt lgkmcnt(4)
  v_pk_add_f32 v[44:45], v[44:45], v[76:77]
  v_pk_add_f32 v[46:47], v[46:47], v[78:79]
  s_waitcnt lgkmcnt(3)
  v_pk_add_f32 v[32:33], v[32:33], v[80:81]
  v_pk_add_f32 v[34:35], v[34:35], v[82:83]
  s_waitcnt lgkmcnt(2)
  v_pk_add_f32 v[36:37], v[36:37], v[84:85]
  v_pk_add_f32 v[38:39], v[38:39], v[86:87]
  s_waitcnt lgkmcnt(1)
  v_pk_add_f32 v[40:41], v[40:41], v[88:89]
  v_pk_add_f32 v[42:43], v[42:43], v[90:91]
  s_waitcnt lgkmcnt(0)
  v_pk_add_f32 v[44:45], v[44:45], v[92:93]
  v_pk_add_f32 v[46:47], v[46:47], v[94:95]
  v_cvt_pk_bf16_f32 v48, v32, v33
  v_cvt_pk_bf16_f32 v49, v34, v35
  v_cvt_pk_bf16_f32 v50, v36, v37
  v_cvt_pk_bf16_f32 v51, v38, v39
  v_cvt_pk_bf16_f32 v52, v40, v41
  v_cvt_pk_bf16_f32 v53, v42, v43
  v_cvt_pk_bf16_f32 v54, v44, v45
  v_cvt_pk_bf16_f32 v55, v46, v47
  s_add_u32 s44, s32, 24641536
  buffer_store_dwordx4 v[48:51], v1, s[4:7], s44 offen sc1
  buffer_store_dwordx4 v[52:55], v1, s[4:7], s44 offen offset:1024 sc1
  v_dot2_f32_bf16 v27, v48, v8, 0
  v_dot2_f32_bf16 v28, v48, v48, 0
  v_dot2_f32_bf16 v27, v49, v8, v27
  v_dot2_f32_bf16 v28, v49, v49, v28
  v_dot2_f32_bf16 v27, v50, v8, v27
  v_dot2_f32_bf16 v28, v50, v50, v28
  v_dot2_f32_bf16 v27, v51, v8, v27
  v_dot2_f32_bf16 v28, v51, v51, v28
  v_dot2_f32_bf16 v27, v52, v8, v27
  v_dot2_f32_bf16 v28, v52, v52, v28
  v_dot2_f32_bf16 v27, v53, v8, v27
  v_dot2_f32_bf16 v28, v53, v53, v28
  v_dot2_f32_bf16 v27, v54, v8, v27
  v_dot2_f32_bf16 v28, v54, v54, v28
  v_dot2_f32_bf16 v27, v55, v8, v27
  v_dot2_f32_bf16 v28, v55, v55, v28
  s_nop 2
  v_permlane32_swap_b32 v27, v28
  v_add_f32 v27, v27, v28
  s_add_u32 s45, s33, 28835840
  buffer_store_dword v27, v4, s[4:7], s45 offen sc1
  s_add_u32 s64, s77, 1
  v_mov_b32 v29, s64
  s_waitcnt vmcnt(0)
  s_mov_b64 exec, 1
  s_cmp_eq_u32 s76, 0
  s_cbranch_scc1 L_main_pslow_37
  buffer_store_dword v29, off, s[4:7], s101
L_main_pdone_38:
  s_mov_b64 exec, -1
  s_barrier
  s_cbranch_vccnz L_main_skip_39
  s_add_u32 s49, s19, 2236416
  s_add_u32 m0, s15, 49152
  s_nop 0
  buffer_load_dwordx4 v1, s[4:7], s49 offen sc1 lds
  buffer_load_dwordx4 v1, s[4:7], s49 offen offset:1024 sc1 lds
L_main_skip_39:
  s_cbranch_vccnz L_main_skip_40
  buffer_load_dwordx4 v1, s[4:7], s49 offen offset:2048 sc1 lds
  buffer_load_dwordx4 v1, s[4:7], s49 offen offset:3072 sc1 lds
L_main_skip_40:
  s_cbranch_vccnz L_main_skip_41
  s_add_u32 s49, s19, 2269184
  s_add_u32 m0, s15, 65536
  s_nop 0
  buffer_load_dwordx4 v1, s[4:7], s49 offen sc1 lds
  buffer_load_dwordx4 v1, s[4:7], s49 offen offset:1024 sc1 lds
L_main_skip_41:
  s_cbranch_vccnz L_main_skip_42
  buffer_load_dwordx4 v1, s[4:7], s49 offen offset:2048 sc1 lds
  buffer_load_dwordx4 v1, s[4:7], s49 offen offset:3072 sc1 lds
L_main_skip_42:
  s_cbranch_vccnz L_main_skip_43
  s_add_u32 s49, s19, 2301952
  s_add_u32 m0, s15, 81920
  s_nop 0
  buffer_load_dwordx4 v1, s[4:7], s49 offen sc1 lds
  buffer_load_dwordx4 v1, s[4:7], s49 offen offset:1024 sc1 lds
L_main_skip_43:
  s_cbranch_vccnz L_main_skip_44
  buffer_load_dwordx4 v1, s[4:7], s49 offen offset:2048 sc1 lds
  buffer_load_dwordx4 v1, s[4:7], s49 offen offset:3072 sc1 lds
L_main_skip_44:
  buffer_load_dword v30, v10, s[4:7], 0 offen sc1
  s_add_u32 s62, s77, 1
  s_mov_b32 s63, 0
  s_waitcnt vmcnt(0)
  v_cmp_gt_u32 s[64:65], s62, v30
  s_nop 3
  s_cmp_lg_u64 s[64:65], 0
  s_cbranch_scc1 L_main_floop_45
L_main_finv_47:
L_main_fdone_46:
  s_add_u32 s44, s16, 24641536
  buffer_load_dwordx4 a[0:3], v1, s[4:7], s44 offen sc1
  buffer_load_dwordx4 a[4:7], v1, s[4:7], s44 offen offset:1024 sc1
  buffer_load_dwordx4 a[8:11], v1, s[4:7], s44 offen offset:2048 sc1
  buffer_load_dwordx4 a[12:15], v1, s[4:7], s44 offen offset:3072 sc1
  s_add_u32 s44, s16, 24645632
  buffer_load_dwordx4 a[16:19], v1, s[4:7], s44 offen sc1
  buffer_load_dwordx4 a[20:23], v1, s[4:7], s44 offen offset:1024 sc1
  buffer_load_dwordx4 a[24:27], v1, s[4:7], s44 offen offset:2048 sc1
  buffer_load_dwordx4 a[28:31], v1, s[4:7], s44 offen offset:3072 sc1
  ds_read_b128 v[96:99], v1
  ds_read_b128 v[100:103], v1 offset:16384
  ds_read_b128 v[104:107], v1 offset:32768
  ds_read_b128 v[108:111], v1 offset:1024
  ds_read_b128 v[112:115], v1 offset:17408
  ds_read_b128 v[116:119], v1 offset:33792
  ds_read_b128 v[120:123], v1 offset:2048
  s_waitcnt vmcnt(7) lgkmcnt(6)
  v_mfma_f32_32x32x16_bf16 v[32:47], v[96:99], a[0:3], 0
  s_add_u32 s44, s16, 24649728
  buffer_load_dwordx4 a[32:35], v1, s[4:7], s44 offen sc1
  s_add_u32 s45, s17, 28835840
  buffer_load_dword v80, v4, s[4:7], s45 offen sc1
  ds_read_b128 v[124:127], v1 offset:18432
  s_waitcnt lgkmcnt(6)
  v_mfma_f32_32x32x16_bf16 v[48:63], v[100:103], a[0:3], 0
  buffer_load_dword v81, v4, s[4:7], s45 offen offset:256 sc1
  ds_read_b128 v[96:99], v1 offset:34816
  s_waitcnt lgkmcnt(6)
  v_mfma_f32_32x32x16_bf16 v[64:79], v[104:107], a[0:3], 0
  buffer_load_dwordx4 a[36:39], v1, s[4:7], s44 offen offset:1024 sc1
  buffer_load_dword v82, v4, s[4:7], s45 offen offset:512 sc1
  ds_read_b128 v[100:103], v1 offset:3072
  s_waitcnt vmcnt(11) lgkmcnt(6)
  v_mfma_f32_32x32x16_bf16 v[32:47], v[108:111], a[4:7], v[32:47]
  buffer_load_dword v83, v4, s[4:7], s45 offen offset:768 sc1
  ds_read_b128 v[104:107], v1 offset:19456
  s_waitcnt lgkmcnt(6)
  v_mfma_f32_32x32x16_bf16 v[48:63], v[112:115], a[4:7], v[48:63]
  buffer_load_dwordx4 a[40:43], v1, s[4:7], s44 offen offset:2048 sc1
  buffer_load_dword v84, v4, s[4:7], s45 offen offset:1024 sc1
  ds_read_b128 v[108:111], v1 offset:35840
  s_waitcnt lgkmcnt(6)
  v_mfma_f32_32x32x16_bf16 v[64:79], v[116:119], a[4:7], v[64:79]
  buffer_load_dword v85, v4, s[4:7], s45 offen offset:1280 sc1
  ds_read_b128 v[112:115], v1 offset:4096
  s_waitcnt vmcnt(14) lgkmcnt(6)
  v_mfma_f32_32x32x16_bf16 v[32:47], v[120:123], a[8:11], v[32:47]
  buffer_load_dwordx4 a[44:47], v1, s[4:7], s44 offen offset:3072 sc1
  buffer_load_dword v86, v4, s[4:7], s45 offen offset:1536 sc1
  ds_read_b128 v[116:119], v1 offset:20480
  s_waitcnt lgkmcnt(6)
  v_mfma_f32_32x32x16_bf16 v[48:63], v[124:127], a[8:11], v[48:63]
  buffer_load_dword v87, v4, s[4:7], s45 offen offset:1792 sc1
  ds_read_b128 v[120:123], v1 offset:36864
  s_waitcnt lgkmcnt(6)
  v_mfma_f32_32x32x16_bf16 v[64:79], v[96:99], a[8:11], v[64:79]
  s_add_u32 s44, s16, 24653824
  buffer_load_dwordx4 a[48:51], v1, s[4:7], s44 offen sc1
  buffer_load_dword v88, v4, s[4:7], s45 offen offset:2048 sc1
  ds_read_b128 v[124:127], v1 offset:5120
  s_waitcnt vmcnt(18) lgkmcnt(6)
  v_mfma_f32_32x32x16_bf16 v[32:47], v[100:103], a[12:15], v[32:47]
  buffer_load_dword v89, v4, s[4:7], s45 offen offset:2304 sc1
  ds_read_b128 v[96:99], v1 offset:21504
  s_waitcnt lgkmcnt(6)
  v_mfma_f32_32x32x16_bf16 v[48:63], v[104:107], a[12:15], v[48:63]
  buffer_load_dwordx4 a[52:55], v1, s[4:7], s44 offen offset:1024 sc1
  buffer_load_dword v90, v4, s[4:7], s45 offen offset:2560 sc1
  ds_read_b128 v[100:103], v1 offset:37888
  s_waitcnt lgkmcnt(6)
  v_mfma_f32_32x32x16_bf16 v[64:79], v[108:111], a[12:15], v[64:79]
  buffer_load_dword v91, v4, s[4:7], s45 offen offset:2816 sc1
  ds_read_b128 v[104:107], v1 offset:6144
  s_waitcnt vmcnt(21) lgkmcnt(6)
  v_mfma_f32_32x32x16_bf16 v[32:47], v[112:115], a[16:19], v[32:47]
  buffer_load_dwordx4 a[56:59], v1, s[4:7], s44 offen offset:2048 sc1
  buffer_load_dword v92, v4, s[4:7], s45 offen offset:3072 sc1
  ds_read_b128 v[108:111], v1 offset:22528
  s_waitcnt lgkmcnt(6)
  v_mfma_f32_32x32x16_bf16 v[48:63], v[116:119], a[16:19], v[48:63]
  buffer_load_dword v93, v4, s[4:7], s45 offen offset:3328 sc1
  ds_read_b128 v[112:115], v1 offset:38912
  s_waitcnt lgkmcnt(6)
  v_mfma_f32_32x32x16_bf16 v[64:79], v[120:123], a[16:19], v[64:79]
  buffer_load_dwordx4 a[60:63], v1, s[4:7], s44 offen offset:3072 sc1
  buffer_load_dword v94, v4, s[4:7], s45 offen offset:3584 sc1
  ds_read_b128 v[116:119], v1 offset:7168
  s_waitcnt vmcnt(25) lgkmcnt(6)
  v_mfma_f32_32x32x16_bf16 v[32:47], v[124:127], a[20:23], v[32:47]
  buffer_load_dword v95, v4, s[4:7], s45 offen offset:3840 sc1
  ds_read_b128 v[120:123], v1 offset:23552
  s_waitcnt lgkmcnt(6)
  v_mfma_f32_32x32x16_bf16 v[48:63], v[96:99], a[20:23], v[48:63]
  s_add_u32 s44, s16, 24657920
  buffer_load_dwordx4 a[64:67], v1, s[4:7], s44 offen sc1
  ds_read_b128 v[124:127], v1 offset:39936
  s_waitcnt lgkmcnt(6)
  v_mfma_f32_32x32x16_bf16 v[64:79], v[100:103], a[20:23], v[64:79]
  ds_read_b128 v[96:99], v1 offset:8192
  s_waitcnt vmcnt(26) lgkmcnt(6)
  v_mfma_f32_32x32x16_bf16 v[32:47], v[104:107], a[24:27], v[32:47]
  buffer_load_dwordx4 a[68:71], v1, s[4:7], s44 offen offset:1024 sc1
  ds_read_b128 v[100:103], v1 offset:24576
  s_waitcnt lgkmcnt(6)
  v_mfma_f32_32x32x16_bf16 v[48:63], v[108:111], a[24:27], v[48:63]
  ds_read_b128 v[104:107], v1 offset:40960
  s_waitcnt lgkmcnt(6)
  v_mfma_f32_32x32x16_bf16 v[64:79], v[112:115], a[24:27], v[64:79]
  buffer_load_dwordx4 a[72:75], v1, s[4:7], s44 offen offset:2048 sc1
  ds_read_b128 v[108:111], v1 offset:9216
  s_waitcnt vmcnt(27) lgkmcnt(6)
  v_mfma_f32_32x32x16_bf16 v[32:47], v[116:119], a[28:31], v[32:47]
  ds_read_b128 v[112:115], v1 offset:25600
  s_waitcnt lgkmcnt(6)
  v_mfma_f32_32x32x16_bf16 v[48:63], v[120:123], a[28:31], v[48:63]
  buffer_load_dwordx4 a[76:79], v1, s[4:7], s44 offen offset:3072 sc1
  ds_read_b128 v[116:119], v1 offset:41984
  s_waitcnt lgkmcnt(6)
  v_mfma_f32_32x32x16_bf16 v[64:79], v[124:127], a[28:31], v[64:79]
  ds_read_b128 v[120:123], v1 offset:10240
  s_waitcnt vmcnt(27) lgkmcnt(6)
  v_mfma_f32_32x32x16_bf16 v[32:47], v[96:99], a[32:35], v[32:47]
  s_add_u32 s44, s16, 24662016
  buffer_load_dwordx4 a[80:83], v1, s[4:7], s44 offen sc1
  ds_read_b128 v[124:127], v1 offset:26624
  s_waitcnt lgkmcnt(6)
  v_mfma_f32_32x32x16_bf16 v[48:63], v[100:103], a[32:35], v[48:63]
  ds_read_b128 v[96:99], v1 offset:43008
  s_waitcnt lgkmcnt(6)
  v_mfma_f32_32x32x16_bf16 v[64:79], v[104:107], a[32:35], v[64:79]
  buffer_load_dwordx4 a[84:87], v1, s[4:7], s44 offen offset:1024 sc1
  ds_read_b128 v[100:103], v1 offset:11264
  s_waitcnt vmcnt(26) lgkmcnt(6)
  v_mfma_f32_32x32x16_bf16 v[32:47], v[108:111], a[36:39], v[32:47]
  ds_read_b128 v[104:107], v1 offset:27648
  s_waitcnt lgkmcnt(6)
  v_mfma_f32_32x32x16_bf16 v[48:63], v[112:115], a[36:39], v[48:63]
  buffer_load_dwordx4 a[88:91], v1, s[4:7], s44 offen offset:2048 sc1
  ds_read_b128 v[108:111], v1 offset:44032
  s_waitcnt lgkmcnt(6)
  v_mfma_f32_32x32x16_bf16 v[64:79], v[116:119], a[36:39], v[64:79]
  ds_read_b128 v[112:115], v1 offset:12288
  s_waitcnt vmcnt(24) lgkmcnt(6)
  v_mfma_f32_32x32x16_bf16 v[32:47], v[120:123], a[40:43], v[32:47]
  buffer_load_dwordx4 a[92:95], v1, s[4:7], s44 offen offset:3072 sc1
  ds_read_b128 v[116:119], v1 offset:28672
  s_waitcnt lgkmcnt(6)
  v_mfma_f32_32x32x16_bf16 v[48:63], v[124:127], a[40:43], v[48:63]
  ds_read_b128 v[120:123], v1 offset:45056
  s_waitcnt lgkmcnt(6)
  v_mfma_f32_32x32x16_bf16 v[64:79], v[96:99], a[40:43], v[64:79]
  s_add_u32 s44, s16, 24666112
  buffer_load_dwordx4 a[96:99], v1, s[4:7], s44 offen sc1
  ds_read_b128 v[124:127], v1 offset:13312
  s_waitcnt vmcnt(23) lgkmcnt(6)
  v_mfma_f32_32x32x16_bf16 v[32:47], v[100:103], a[44:47], v[32:47]
  ds_read_b128 v[96:99], v1 offset:29696
  s_waitcnt lgkmcnt(6)
  v_mfma_f32_32x32x16_bf16 v[48:63], v[104:107], a[44:47], v[48:63]
  buffer_load_dwordx4 a[100:103], v1, s[4:7], s44 offen offset:1024 sc1
  ds_read_b128 v[100:103], v1 offset:46080
  s_waitcnt lgkmcnt(6)
  v_mfma_f32_32x32x16_bf16 v[64:79], v[108:111], a[44:47], v[64:79]
  ds_read_b128 v[104:107], v1 offset:14336
  s_waitcnt vmcnt(21) lgkmcnt(6)
  v_mfma_f32_32x32x16_bf16 v[32:47], v[112:115], a[48:51], v[32:47]
  buffer_load_dwordx4 a[104:107], v1, s[4:7], s44 offen offset:2048 sc1
  ds_read_b128 v[108:111], v1 offset:30720
  s_waitcnt lgkmcnt(6)
  v_mfma_f32_32x32x16_bf16 v[48:63], v[116:119], a[48:51], v[48:63]
  ds_read_b128 v[112:115], v1 offset:47104
  s_waitcnt lgkmcnt(6)
  v_mfma_f32_32x32x16_bf16 v[64:79], v[120:123], a[48:51], v[64:79]
  buffer_load_dwordx4 a[108:111], v1, s[4:7], s44 offen offset:3072 sc1
  ds_read_b128 v[116:119], v1 offset:15360
  s_waitcnt vmcnt(20) lgkmcnt(6)
  v_mfma_f32_32x32x16_bf16 v[32:47], v[124:127], a[52:55], v[32:47]
  ds_read_b128 v[120:123], v1 offset:31744
  s_waitcnt lgkmcnt(6)
  v_mfma_f32_32x32x16_bf16 v[48:63], v[96:99], a[52:55], v[48:63]
  s_add_u32 s44, s16, 24670208
  buffer_load_dwordx4 a[112:115], v1, s[4:7], s44 offen sc1
  v_add_f32 v80, v80, v88
  ds_read_b128 v[124:127], v1 offset:48128
  s_waitcnt lgkmcnt(6)
  v_mfma_f32_32x32x16_bf16 v[64:79], v[100:103], a[52:55], v[64:79]
  v_add_f32 v81, v81, v89
  s_barrier
  ds_read_b128 v[96:99], v1 offset:49152
  s_waitcnt vmcnt(18) lgkmcnt(6)
  v_mfma_f32_32x32x16_bf16 v[32:47], v[104:107], a[56:59], v[32:47]
  buffer_load_dwordx4 a[116:119], v1, s[4:7], s44 offen offset:1024 sc1
  v_add_f32 v82, v82, v90
  ds_read_b128 v[100:103], v2
  s_waitcnt lgkmcnt(6)
  v_mfma_f32_32x32x16_bf16 v[48:63], v[108:111], a[56:59], v[48:63]
  v_add_f32 v83, v83, v91
  ds_read_b128 v[104:107], v2 offset:16384
  s_waitcnt lgkmcnt(6)
  v_mfma_f32_32x32x16_bf16 v[64:79], v[112:115], a[56:59], v[64:79]
  buffer_load_dwordx4 a[120:123], v1, s[4:7], s44 offen offset:2048 sc1
  s_cbranch_vccnz L_main_skip_49
  s_add_u32 s47, s30, 6004736
  buffer_load_dwordx4 a[128:131], v1, s[4:7], s47 offen sc1
  s_add_u32 s48, s31, 6004736
  buffer_load_dwordx4 a[132:135], v1, s[4:7], s48 offen sc1
  s_add_u32 s47, s30, 6004736
  buffer_load_dwordx4 a[136:139], v1, s[4:7], s47 offen offset:1024 sc1
  s_add_u32 s48, s31, 6004736
  buffer_load_dwordx4 a[140:143], v1, s[4:7], s48 offen offset:1024 sc1
L_main_skip_49:
  ds_read_b128 v[108:111], v1 offset:50176
  s_waitcnt vmcnt(21) lgkmcnt(6)
  s_cbranch_vccz L_main_w_96
  s_waitcnt vmcnt(17)
L_main_w_96:
  v_mfma_f32_32x32x16_bf16 v[32:47], v[116:119], a[60:63], v[32:47]
  v_add_f32 v84, v84, v92
  ds_read_b128 v[112:115], v2 offset:1024
  s_waitcnt lgkmcnt(6)
  v_mfma_f32_32x32x16_bf16 v[48:63], v[120:123], a[60:63], v[48:63]
  buffer_load_dwordx4 a[124:127], v1, s[4:7], s44 offen offset:3072 sc1
  v_add_f32 v85, v85, v93
  ds_read_b128 v[116:119], v2 offset:17408
  s_waitcnt lgkmcnt(6)
  v_mfma_f32_32x32x16_bf16 v[64:79], v[124:127], a[60:63], v[64:79]
  s_waitcnt vmcnt(21)
  s_cbranch_vccz L_main_w_97
  s_waitcnt vmcnt(17)
L_main_w_97:
  v_add_f32 v86, v86, v94
  ds_read_b128 v[120:123], v1 offset:51200
  s_waitcnt vmcnt(19) lgkmcnt(6)
  s_cbranch_vccz L_main_w_98
  s_waitcnt vmcnt(15)
L_main_w_98:
  v_mfma_f32_32x32x16_bf16 v[32:47], v[96:99], a[64:67], v[32:47]
  s_add_u32 s46, s21, 5890048
  buffer_load_dwordx2 v[132:133], v11, s[4:7], s46 offen sc1
  buffer_load_dwordx2 v[134:135], v11, s[4:7], s46 offen offset:256 sc1
  ds_read_b128 v[124:127], v2 offset:2048
  s_waitcnt lgkmcnt(6)
  v_mfma_f32_32x32x16_bf16 v[48:63], v[100:103], a[64:67], v[48:63]
  v_add_f32 v87, v87, v95
  ds_read_b128 v[96:99], v2 offset:18432
  s_waitcnt lgkmcnt(6)
  v_mfma_f32_32x32x16_bf16 v[64:79], v[104:107], a[64:67], v[64:79]
  v_add_f32 v80, v80, v84
  buffer_load_dwordx2 v[136:137], v11, s[4:7], s46 offen offset:1024 sc1
  buffer_load_dwordx2 v[138:139], v11, s[4:7], s46 offen offset:1280 sc1
  ds_read_b128 v[100:103], v1 offset:52224
  s_waitcnt vmcnt(22) lgkmcnt(6)
  s_cbranch_vccz L_main_w_99
  s_waitcnt vmcnt(18)
L_main_w_99:
  v_mfma_f32_32x32x16_bf16 v[32:47], v[108:111], a[68:71], v[32:47]
  v_add_f32 v81, v81, v85
  ds_read_b128 v[104:107], v2 offset:3072
  s_waitcnt lgkmcnt(6)
  v_mfma_f32_32x32x16_bf16 v[48:63], v[112:115], a[68:71], v[48:63]
  v_add_f32 v82, v82, v86
  ds_read_b128 v[108:111], v2 offset:19456
  s_waitcnt lgkmcnt(6)
  v_mfma_f32_32x32x16_bf16 v[64:79], v[116:119], a[68:71], v[64:79]
  buffer_load_dwordx2 v[140:141], v11, s[4:7], s46 offen offset:2048 sc1
  buffer_load_dwordx2 v[142:143], v11, s[4:7], s46 offen offset:2304 sc1
  ds_read_b128 v[112:115], v1 offset:53248
  s_waitcnt vmcnt(23) lgkmcnt(6)
  s_cbranch_vccz L_main_w_100
  s_waitcnt vmcnt(19)
L_main_w_100:
  v_mfma_f32_32x32x16_bf16 v[32:47], v[120:123], a[72:75], v[32:47]
  v_add_f32 v83, v83, v87
  ds_read_b128 v[116:119], v2 offset:4096
  s_waitcnt lgkmcnt(6)
  v_mfma_f32_32x32x16_bf16 v[48:63], v[124:127], a[72:75], v[48:63]
  v_add_f32 v80, v80, v82
  s_add_u32 s49, s19, 2318336
  s_add_u32 m0, s15, 98304
  s_nop 0
  buffer_load_dwordx4 v1, s[4:7], s49 offen sc1 lds
  s_cbranch_vccnz L_main_skip_50
  s_add_u32 s47, s30, 6004736
  buffer_load_dwordx4 a[144:147], v1, s[4:7], s47 offen offset:2048 sc1
  s_add_u32 s48, s31, 6004736
  buffer_load_dwordx4 a[148:151], v1, s[4:7], s48 offen offset:2048 sc1
  s_add_u32 s47, s30, 6004736
  buffer_load_dwordx4 a[152:155], v1, s[4:7], s47 offen offset:3072 sc1
  s_add_u32 s48, s31, 6004736
  buffer_load_dwordx4 a[156:159], v1, s[4:7], s48 offen offset:3072 sc1
L_main_skip_50:
  ds_read_b128 v[120:123], v2 offset:20480
  s_waitcnt lgkmcnt(6)
  v_mfma_f32_32x32x16_bf16 v[64:79], v[96:99], a[72:75], v[64:79]
  v_add_f32 v81, v81, v83
  ds_read_b128 v[124:127], v1 offset:54272
  s_waitcnt vmcnt(27) lgkmcnt(6)
  s_cbranch_vccz L_main_w_101
  s_waitcnt vmcnt(19)
L_main_w_101:
  v_mfma_f32_32x32x16_bf16 v[32:47], v[100:103], a[76:79], v[32:47]
  ds_read_b128 v[96:99], v2 offset:5120
  s_waitcnt lgkmcnt(6)
  v_mfma_f32_32x32x16_bf16 v[48:63], v[104:107], a[76:79], v[48:63]
  v_add_f32 v80, v80, v81
  buffer_load_dwordx4 v1, s[4:7], s49 offen offset:1024 sc1 lds
  ds_read_b128 v[100:103], v2 offset:21504
  s_waitcnt lgkmcnt(6)
  v_mfma_f32_32x32x16_bf16 v[64:79], v[108:111], a[76:79], v[64:79]
  v_mov_b32 v81, v80
  ds_read_b128 v[104:107], v1 offset:55296
  s_waitcnt vmcnt(27) lgkmcnt(6)
  s_cbranch_vccz L_main_w_102
  s_waitcnt vmcnt(19)
L_main_w_102:
  v_mfma_f32_32x32x16_bf16 v[32:47], v[112:115], a[80:83], v[32:47]
  v_permlane32_swap_b32 v80, v81
  buffer_load_dwordx4 v1, s[4:7], s49 offen offset:2048 sc1 lds
  ds_read_b128 v[108:111], v2 offset:6144
  s_waitcnt lgkmcnt(6)
  v_mfma_f32_32x32x16_bf16 v[48:63], v[116:119], a[80:83], v[48:63]
  v_mul_f32 v80, 0xbb000000, v80
  ds_read_b128 v[112:115], v2 offset:22528
  s_waitcnt lgkmcnt(6)
  v_mfma_f32_32x32x16_bf16 v[64:79], v[120:123], a[80:83], v[64:79]
  ds_read_b128 v[116:119], v1 offset:56320
  s_waitcnt vmcnt(27) lgkmcnt(6)
  s_cbranch_vccz L_main_w_103
  s_waitcnt vmcnt(19)
L_main_w_103:
  v_mfma_f32_32x32x16_bf16 v[32:47], v[124:127], a[84:87], v[32:47]
  v_mul_f32 v81, 0x3b000000, v81
  buffer_load_dwordx4 v1, s[4:7], s49 offen offset:3072 sc1 lds
  ds_read_b128 v[120:123], v2 offset:7168
  s_waitcnt lgkmcnt(6)
  v_mfma_f32_32x32x16_bf16 v[48:63], v[96:99], a[84:87], v[48:63]
  v_fma_f32 v81, -v80, v80, v81
  ds_read_b128 v[124:127], v2 offset:23552
  s_waitcnt lgkmcnt(6)
  v_mfma_f32_32x32x16_bf16 v[64:79], v[100:103], a[84:87], v[64:79]
  v_max_f32 v81, 0, v81
  s_add_u32 s49, s19, 2334720
  s_add_u32 m0, s15, 114688
  s_nop 0
  buffer_load_dwordx4 v1, s[4:7], s49 offen sc1 lds
  ds_read_b128 v[96:99], v1 offset:57344
  s_waitcnt vmcnt(28) lgkmcnt(6)
  s_cbranch_vccz L_main_w_104
  s_waitcnt vmcnt(20)
L_main_w_104:
  v_mfma_f32_32x32x16_bf16 v[32:47], v[104:107], a[88:91], v[32:47]
  ds_read_b128 v[100:103], v2 offset:8192
  s_waitcnt lgkmcnt(6)
  v_mfma_f32_32x32x16_bf16 v[48:63], v[108:111], a[88:91], v[48:63]
  v_add_f32 v81, 0x3727c5ac, v81
  s_cbranch_vccnz L_main_skip_51
  s_add_u32 s47, s30, 6008832
  buffer_load_dwordx4 a[160:163], v1, s[4:7], s47 offen sc1
  s_add_u32 s48, s31, 6008832
  buffer_load_dwordx4 a[164:167], v1, s[4:7], s48 offen sc1
  s_add_u32 s47, s30, 6008832
  buffer_load_dwordx4 a[168:171], v1, s[4:7], s47 offen offset:3072 sc1
  s_add_u32 s48, s31, 6008832
  buffer_load_dwordx4 a[172:175], v1, s[4:7], s48 offen offset:3072 sc1
L_main_skip_51:
  ds_read_b128 v[104:107], v2 offset:24576
  s_waitcnt lgkmcnt(6)
  v_mfma_f32_32x32x16_bf16 v[64:79], v[112:115], a[88:91], v[64:79]
  v_rsq_f32 v18, v81
  buffer_load_dwordx4 v1, s[4:7], s49 offen offset:1024 sc1 lds
  ds_read_b128 v[108:111], v1 offset:58368
  s_waitcnt vmcnt(32) lgkmcnt(6)
  s_cbranch_vccz L_main_w_105
  s_waitcnt vmcnt(20)
L_main_w_105:
  v_mfma_f32_32x32x16_bf16 v[32:47], v[116:119], a[92:95], v[32:47]
  v_cvt_pk_bf16_f32 v82, v80, v80
  ds_read_b128 v[112:115], v2 offset:9216
  s_waitcnt lgkmcnt(6)
  v_mfma_f32_32x32x16_bf16 v[48:63], v[120:123], a[92:95], v[48:63]
  v_and_b32 v82, 0xffff0000, v82
  buffer_load_dwordx4 v1, s[4:7], s49 offen offset:2048 sc1 lds
  ds_read_b128 v[116:119], v2 offset:25600
  s_waitcnt lgkmcnt(6)
  v_mfma_f32_32x32x16_bf16 v[64:79], v[124:127], a[92:95], v[64:79]
  ds_read_b128 v[120:123], v1 offset:59392
  s_waitcnt vmcnt(32) lgkmcnt(6)
  s_cbranch_vccz L_main_w_106
  s_waitcnt vmcnt(20)
L_main_w_106:
  v_mfma_f32_32x32x16_bf16 v[32:47], v[96:99], a[96:99], v[32:47]
  v_sub_f32 v82, v80, v82
  ds_read_b128 v[124:127], v2 offset:10240
  s_waitcnt lgkmcnt(6)
  v_mfma_f32_32x32x16_bf16 v[48:63], v[100:103], a[96:99], v[48:63]
  v_cvt_pk_bf16_f32 v20, v80, v82
  buffer_load_dwordx4 v1, s[4:7], s49 offen offset:3072 sc1 lds
  ds_read_b128 v[96:99], v2 offset:26624
  s_waitcnt lgkmcnt(6)
  v_mfma_f32_32x32x16_bf16 v[64:79], v[104:107], a[96:99], v[64:79]
  v_mul_f32 v19, v18, v18
  ds_read_b128 v[100:103], v1 offset:60416
  s_waitcnt vmcnt(32) lgkmcnt(6)
  s_cbranch_vccz L_main_w_107
  s_waitcnt vmcnt(20)
L_main_w_107:
  v_mfma_f32_32x32x16_bf16 v[32:47], v[108:111], a[100:103], v[32:47]
  buffer_load_dwordx2 v[144:145], v11, s[4:7], s46 offen offset:3072 sc1
  buffer_load_dwordx2 v[146:147], v11, s[4:7], s46 offen offset:3328 sc1
  ds_read_b128 v[104:107], v2 offset:11264
  s_waitcnt lgkmcnt(6)
  v_mfma_f32_32x32x16_bf16 v[48:63], v[112:115], a[100:103], v[48:63]
  v_mov_b32 v21, v20
  ds_read_b128 v[108:111], v2 offset:27648
  s_waitcnt lgkmcnt(6)
  v_mfma_f32_32x32x16_bf16 v[64:79], v[116:119], a[100:103], v[64:79]
  v_mov_b32 v22, v20
  ds_read_b128 v[112:115], v1 offset:61440
  s_waitcnt vmcnt(33) lgkmcnt(6)
  s_cbranch_vccz L_main_w_108
  s_waitcnt vmcnt(21)
L_main_w_108:
  v_mfma_f32_32x32x16_bf16 v[32:47], v[120:123], a[104:107], v[32:47]
  v_mov_b32 v23, v20
  s_add_u32 s46, s21, 5894144
  buffer_load_dwordx2 v[148:149], v11, s[4:7], s46 offen sc1
  buffer_load_dwordx2 v[150:151], v11, s[4:7], s46 offen offset:256 sc1
  s_cbranch_vccnz L_main_skip_52
  s_add_u32 s47, s30, 6012928
  buffer_load_dwordx4 a[176:179], v1, s[4:7], s47 offen sc1
  s_add_u32 s48, s31, 6012928
  buffer_load_dwordx4 a[180:183], v1, s[4:7], s48 offen sc1
  s_add_u32 s47, s30, 6012928
  buffer_load_dwordx4 a[184:187], v1, s[4:7], s47 offen offset:1024 sc1
  s_add_u32 s48, s31, 6012928
  buffer_load_dwordx4 a[188:191], v1, s[4:7], s48 offen offset:1024 sc1
L_main_skip_52:
  ds_read_b128 v[116:119], v2 offset:12288
  s_waitcnt lgkmcnt(6)
  v_mfma_f32_32x32x16_bf16 v[48:63], v[124:127], a[104:107], v[48:63]
  ds_read_b128 v[120:123], v2 offset:28672
  s_waitcnt lgkmcnt(6)
  v_mfma_f32_32x32x16_bf16 v[64:79], v[96:99], a[104:107], v[64:79]
  buffer_load_dwordx2 v[152:153], v11, s[4:7], s46 offen offset:1024 sc1
  buffer_load_dwordx2 v[154:155], v11, s[4:7], s46 offen offset:1280 sc1
  ds_read_b128 v[124:127], v1 offset:62464
  s_waitcnt vmcnt(40) lgkmcnt(6)
  s_cbranch_vccz L_main_w_109
  s_waitcnt vmcnt(24)
L_main_w_109:
  v_mfma_f32_32x32x16_bf16 v[32:47], v[100:103], a[108:111], v[32:47]
  ds_read_b128 v[96:99], v2 offset:13312
  s_waitcnt lgkmcnt(6)
  v_mfma_f32_32x32x16_bf16 v[48:63], v[104:107], a[108:111], v[48:63]
  ds_read_b128 v[100:103], v2 offset:29696
  s_waitcnt lgkmcnt(6)
  v_mfma_f32_32x32x16_bf16 v[64:79], v[108:111], a[108:111], v[64:79]
  buffer_load_dwordx2 v[156:157], v11, s[4:7], s46 offen offset:2048 sc1
  buffer_load_dwordx2 v[158:159], v11, s[4:7], s46 offen offset:2304 sc1
  ds_read_b128 v[104:107], v1 offset:63488
  s_waitcnt vmcnt(41) lgkmcnt(6)
  s_cbranch_vccz L_main_w_110
  s_waitcnt vmcnt(25)
L_main_w_110:
  v_mfma_f32_32x32x16_bf16 v[32:47], v[112:115], a[112:115], v[32:47]
  ds_read_b128 v[108:111], v2 offset:14336
  s_waitcnt lgkmcnt(6)
  v_mfma_f32_32x32x16_bf16 v[48:63], v[116:119], a[112:115], v[48:63]
  s_add_u32 s49, s19, 2351104
  s_add_u32 m0, s15, 131072
  s_nop 0
  buffer_load_dwordx4 v1, s[4:7], s49 offen sc1 lds
  ds_read_b128 v[112:115], v2 offset:30720
  s_waitcnt lgkmcnt(6)
  v_mfma_f32_32x32x16_bf16 v[64:79], v[120:123], a[112:115], v[64:79]
  ds_read_b128 v[116:119], v1 offset:64512
  s_waitcnt vmcnt(41) lgkmcnt(6)
  s_cbranch_vccz L_main_w_111
  s_waitcnt vmcnt(25)
L_main_w_111:
  v_mfma_f32_32x32x16_bf16 v[32:47], v[124:127], a[116:119], v[32:47]
  ds_read_b128 v[120:123], v2 offset:15360
  s_waitcnt lgkmcnt(6)
  v_mfma_f32_32x32x16_bf16 v[48:63], v[96:99], a[116:119], v[48:63]
  buffer_load_dwordx4 v1, s[4:7], s49 offen offset:1024 sc1 lds
  ds_read_b128 v[124:127], v2 offset:31744
  s_waitcnt lgkmcnt(6)
  v_mfma_f32_32x32x16_bf16 v[64:79], v[100:103], a[116:119], v[64:79]
  s_waitcnt vmcnt(22)
  s_cbranch_vccz L_main_w_112
  s_waitcnt vmcnt(14)
L_main_w_112:
  s_barrier
  ds_read_b128 v[96:99], v2 offset:32768
  s_waitcnt lgkmcnt(6)
  v_mfma_f32_32x32x16_bf16 v[32:47], v[104:107], a[120:123], v[32:47]
  buffer_load_dwordx4 v1, s[4:7], s49 offen offset:2048 sc1 lds
  ds_read_b128 v[100:103], v2 offset:33792
  s_waitcnt lgkmcnt(6)
  v_mfma_f32_32x32x16_bf16 v[48:63], v[108:111], a[120:123], v[48:63]
  ds_read_b128 v[104:107], v2 offset:34816
  s_waitcnt lgkmcnt(6)
  v_mfma_f32_32x32x16_bf16 v[64:79], v[112:115], a[120:123], v[64:79]
  ds_read_b128 v[108:111], v2 offset:35840
  s_waitcnt lgkmcnt(6)
  v_mfma_f32_32x32x16_bf16 v[32:47], v[116:119], a[124:127], v[32:47]
  buffer_load_dwordx4 v1, s[4:7], s49 offen offset:3072 sc1 lds
  ds_read_b128 v[112:115], v2 offset:36864
  s_waitcnt lgkmcnt(6)
  v_mfma_f32_32x32x16_bf16 v[48:63], v[120:123], a[124:127], v[48:63]
  ds_read_b128 v[116:119], v2 offset:37888
  s_waitcnt lgkmcnt(6)
  v_mfma_f32_32x32x16_bf16 v[64:79], v[124:127], a[124:127], v[64:79]
  s_add_u32 s49, s19, 2367488
  s_add_u32 m0, s15, 147456
  s_nop 0
  buffer_load_dwordx4 v1, s[4:7], s49 offen sc1 lds
  v_mfma_f32_32x32x16_bf16 v[32:47], v[132:135], v[20:23], v[32:47]
  v_mfma_f32_32x32x16_bf16 v[48:63], v[136:139], v[20:23], v[48:63]
  v_mfma_f32_32x32x16_bf16 v[64:79], v[140:143], v[20:23], v[64:79]
  buffer_load_dwordx4 v1, s[4:7], s49 offen offset:1024 sc1 lds
  ds_read_b128 v[120:123], v2 offset:38912
  s_waitcnt lgkmcnt(6)
  v_mfma_f32_32x32x16_bf16 v[80:95], v[96:99], a[0:3], 0
  ds_read_b128 v[124:127], v2 offset:39936
  s_waitcnt lgkmcnt(6)
  v_mfma_f32_32x32x16_bf16 v[80:95], v[100:103], a[4:7], v[80:95]
  buffer_load_dwordx4 v1, s[4:7], s49 offen offset:2048 sc1 lds
  s_nop 1
  v_mul_f32 v32, v32, v19
  v_mul_f32 v32, v32, v40
  v_mul_f32 v33, v33, v19
  ds_read_b128 v[96:99], v2 offset:40960
  s_waitcnt lgkmcnt(6)
  v_mfma_f32_32x32x16_bf16 v[80:95], v[104:107], a[8:11], v[80:95]
  v_mul_f32 v33, v33, v41
  v_cvt_pk_bf16_f32 v40, v32, v33
  ds_read_b128 v[100:103], v2 offset:41984
  s_waitcnt lgkmcnt(6)
  v_mfma_f32_32x32x16_bf16 v[80:95], v[108:111], a[12:15], v[80:95]
  v_mul_f32 v34, v34, v19
  v_mul_f32 v34, v34, v42
  ds_read_b128 v[104:107], v2 offset:43008
  s_waitcnt lgkmcnt(6)
  v_mfma_f32_32x32x16_bf16 v[80:95], v[112:115], a[16:19], v[80:95]
  buffer_load_dwordx4 v1, s[4:7], s49 offen offset:3072 sc1 lds
  v_mul_f32 v35, v35, v19
  v_mul_f32 v35, v35, v43
  v_cvt_pk_bf16_f32 v41, v34, v35
  ds_read_b128 v[108:111], v2 offset:44032
  s_waitcnt lgkmcnt(6)
  v_mfma_f32_32x32x16_bf16 v[80:95], v[116:119], a[20:23], v[80:95]
  v_mul_f32 v36, v36, v19
  v_mul_f32 v36, v36, v44
  ds_read_b128 v[112:115], v2 offset:45056
  s_waitcnt lgkmcnt(6)
  v_mfma_f32_32x32x16_bf16 v[80:95], v[120:123], a[24:27], v[80:95]
  v_mul_f32 v37, v37, v19
  v_mul_f32 v37, v37, v45
  ds_read_b128 v[116:119], v2 offset:46080
  s_waitcnt lgkmcnt(6)
  v_mfma_f32_32x32x16_bf16 v[80:95], v[124:127], a[28:31], v[80:95]
  v_cvt_pk_bf16_f32 v42, v36, v37
  v_mul_f32 v38, v38, v19
  v_mul_f32 v38, v38, v46
  ds_read_b128 v[120:123], v2 offset:47104
  s_waitcnt lgkmcnt(6)
  v_mfma_f32_32x32x16_bf16 v[80:95], v[96:99], a[32:35], v[80:95]
  v_mul_f32 v39, v39, v19
  v_mul_f32 v39, v39, v47
  ds_read_b128 v[124:127], v2 offset:48128
  s_waitcnt lgkmcnt(6)
  v_mfma_f32_32x32x16_bf16 v[80:95], v[100:103], a[36:39], v[80:95]
  v_cvt_pk_bf16_f32 v43, v38, v39
  s_add_u32 s63, s23, 31457280
  buffer_store_dwordx4 v[40:43], v1, s[4:7], s63 offen sc1
  s_waitcnt vmcnt(21)
  s_cbranch_vccz L_main_w_113
  s_waitcnt vmcnt(17)
L_main_w_113:
  s_barrier
  ds_read_b128 v[96:99], v2 offset:49152
  s_waitcnt lgkmcnt(6)
  v_mfma_f32_32x32x16_bf16 v[80:95], v[104:107], a[40:43], v[80:95]
  v_mul_f32 v48, v48, v19
  v_mul_f32 v48, v48, v56
  v_mul_f32 v49, v49, v19
  ds_read_b128 v[100:103], v2 offset:50176
  s_waitcnt lgkmcnt(6)
  v_mfma_f32_32x32x16_bf16 v[80:95], v[108:111], a[44:47], v[80:95]
  v_mul_f32 v49, v49, v57
  v_cvt_pk_bf16_f32 v56, v48, v49
  ds_read_b128 v[104:107], v2 offset:51200
  s_waitcnt lgkmcnt(6)
  v_mfma_f32_32x32x16_bf16 v[80:95], v[112:115], a[48:51], v[80:95]
  v_mul_f32 v50, v50, v19
  v_mul_f32 v50, v50, v58
  s_add_u32 s49, s19, 2383872
  s_add_u32 m0, s15, 81920
  s_nop 0
  buffer_load_dwordx4 v1, s[4:7], s49 offen sc1 lds
  ds_read_b128 v[108:111], v2 offset:52224
  s_waitcnt lgkmcnt(6)
  v_mfma_f32_32x32x16_bf16 v[80:95], v[116:119], a[52:55], v[80:95]
  v_mul_f32 v51, v51, v19
  v_mul_f32 v51, v51, v59
  v_cvt_pk_bf16_f32 v57, v50, v51
  buffer_load_dwordx4 v1, s[4:7], s49 offen offset:1024 sc1 lds
  ds_read_b128 v[112:115], v2 offset:53248
  s_waitcnt lgkmcnt(6)
  v_mfma_f32_32x32x16_bf16 v[80:95], v[120:123], a[56:59], v[80:95]
  v_mul_f32 v52, v52, v19
  v_mul_f32 v52, v52, v60
  ds_read_b128 v[116:119], v2 offset:54272
  s_waitcnt lgkmcnt(6)
  v_mfma_f32_32x32x16_bf16 v[80:95], v[124:127], a[60:63], v[80:95]
  v_mul_f32 v53, v53, v19
  v_mul_f32 v53, v53, v61
  buffer_load_dwordx4 v1, s[4:7], s49 offen offset:2048 sc1 lds
  ds_read_b128 v[120:123], v2 offset:55296
  s_waitcnt lgkmcnt(6)
  v_mfma_f32_32x32x16_bf16 v[80:95], v[96:99], a[64:67], v[80:95]
  v_cvt_pk_bf16_f32 v58, v52, v53
  v_mul_f32 v54, v54, v19
  v_mul_f32 v54, v54, v62
  buffer_load_dwordx4 v1, s[4:7], s49 offen offset:3072 sc1 lds
  ds_read_b128 v[124:127], v2 offset:56320
  s_waitcnt lgkmcnt(6)
  v_mfma_f32_32x32x16_bf16 v[80:95], v[100:103], a[68:71], v[80:95]
  v_mul_f32 v55, v55, v19
  v_mul_f32 v55, v55, v63
  ds_read_b128 v[96:99], v2 offset:57344
  s_waitcnt lgkmcnt(6)
  v_mfma_f32_32x32x16_bf16 v[80:95], v[104:107], a[72:75], v[80:95]
  v_cvt_pk_bf16_f32 v59, v54, v55
  s_add_u32 s63, s23, 31457280
  buffer_store_dwordx4 v[56:59], v1, s[4:7], s63 offen offset:1024 sc1
  s_cbranch_vccnz L_main_skip_53
  s_add_u32 s47, s30, 6012928
  buffer_load_dwordx4 a[192:195], v1, s[4:7], s47 offen offset:2048 sc1
  s_add_u32 s48, s31, 6012928
  buffer_load_dwordx4 a[196:199], v1, s[4:7], s48 offen offset:2048 sc1
  s_add_u32 s47, s30, 6012928
  buffer_load_dwordx4 a[200:203], v1, s[4:7], s47 offen offset:3072 sc1
  s_add_u32 s48, s31, 6012928
  buffer_load_dwordx4 a[204:207], v1, s[4:7], s48 offen offset:3072 sc1
L_main_skip_53:
  ds_read_b128 v[100:103], v2 offset:58368
  s_waitcnt lgkmcnt(6)
  v_mfma_f32_32x32x16_bf16 v[80:95], v[108:111], a[76:79], v[80:95]
  v_mul_f32 v64, v64, v19
  v_mul_f32 v64, v64, v72
  v_mul_f32 v65, v65, v19
  ds_read_b128 v[104:107], v2 offset:59392
  s_waitcnt lgkmcnt(6)
  v_mfma_f32_32x32x16_bf16 v[80:95], v[112:115], a[80:83], v[80:95]
  v_mul_f32 v65, v65, v73
  v_cvt_pk_bf16_f32 v72, v64, v65
  ds_read_b128 v[108:111], v2 offset:60416
  s_waitcnt lgkmcnt(6)
  v_mfma_f32_32x32x16_bf16 v[80:95], v[116:119], a[84:87], v[80:95]
  v_mul_f32 v66, v66, v19
  v_mul_f32 v66, v66, v74
  ds_read_b128 v[112:115], v2 offset:61440
  s_waitcnt lgkmcnt(6)
  v_mfma_f32_32x32x16_bf16 v[80:95], v[120:123], a[88:91], v[80:95]
  v_mul_f32 v67, v67, v19
  v_mul_f32 v67, v67, v75
  v_cvt_pk_bf16_f32 v73, v66, v67
  ds_read_b128 v[116:119], v2 offset:62464
  s_waitcnt lgkmcnt(6)
  v_mfma_f32_32x32x16_bf16 v[80:95], v[124:127], a[92:95], v[80:95]
  v_mul_f32 v68, v68, v19
  v_mul_f32 v68, v68, v76
  s_cbranch_vccnz L_main_skip_54
  s_add_u32 s47, s30, 6017024
  buffer_load_dwordx4 a[208:211], v1, s[4:7], s47 offen offset:2048 sc1
  s_add_u32 s48, s31, 6017024
  buffer_load_dwordx4 a[212:215], v1, s[4:7], s48 offen offset:2048 sc1
  s_add_u32 s47, s30, 6017024
  buffer_load_dwordx4 a[216:219], v1, s[4:7], s47 offen offset:3072 sc1
  s_add_u32 s48, s31, 6017024
  buffer_load_dwordx4 a[220:223], v1, s[4:7], s48 offen offset:3072 sc1
L_main_skip_54:
  ds_read_b128 v[120:123], v2 offset:63488
  s_waitcnt lgkmcnt(6)
  v_mfma_f32_32x32x16_bf16 v[80:95], v[96:99], a[96:99], v[80:95]
  v_mul_f32 v69, v69, v19
  v_mul_f32 v69, v69, v77
  ds_read_b128 v[124:127], v2 offset:64512
  s_waitcnt lgkmcnt(6)
  v_mfma_f32_32x32x16_bf16 v[80:95], v[100:103], a[100:103], v[80:95]
  v_cvt_pk_bf16_f32 v74, v68, v69
  v_mul_f32 v70, v70, v19
  v_mul_f32 v70, v70, v78
  s_waitcnt vmcnt(18)
  s_cbranch_vccz L_main_w_114
  s_waitcnt vmcnt(10)
L_main_w_114:
  s_barrier
  ds_read_b128 v[96:99], v3
  s_waitcnt lgkmcnt(6)
  v_mfma_f32_32x32x16_bf16 v[80:95], v[104:107], a[104:107], v[80:95]
  v_mul_f32 v71, v71, v19
  v_mul_f32 v71, v71, v79
  ds_read_b128 v[100:103], v3 offset:1024
  s_waitcnt lgkmcnt(6)
  v_mfma_f32_32x32x16_bf16 v[80:95], v[108:111], a[108:111], v[80:95]
  v_cvt_pk_bf16_f32 v75, v70, v71
  s_add_u32 s63, s23, 31457280
  buffer_store_dwordx4 v[72:75], v1, s[4:7], s63 offen offset:2048 sc1
  ds_read_b128 v[104:107], v3 offset:2048
  s_waitcnt lgkmcnt(6)
  v_mfma_f32_32x32x16_bf16 v[80:95], v[112:115], a[112:115], v[80:95]
  ds_read_b128 v[108:111], v3 offset:3072
  s_waitcnt lgkmcnt(6)
  v_mfma_f32_32x32x16_bf16 v[80:95], v[116:119], a[116:119], v[80:95]
  s_add_u32 s49, s19, 2400256
  s_add_u32 m0, s15, 98304
  s_nop 0
  buffer_load_dwordx4 v1, s[4:7], s49 offen sc1 lds
  ds_read_b128 v[112:115], v3 offset:4096
  s_waitcnt lgkmcnt(6)
  v_mfma_f32_32x32x16_bf16 v[80:95], v[120:123], a[120:123], v[80:95]
  buffer_load_dwordx4 v1, s[4:7], s49 offen offset:1024 sc1 lds
  ds_read_b128 v[116:119], v3 offset:5120
  s_waitcnt lgkmcnt(6)
  v_mfma_f32_32x32x16_bf16 v[80:95], v[124:127], a[124:127], v[80:95]
  v_mfma_f32_32x32x16_bf16 v[80:95], v[144:147], v[20:23], v[80:95]
  buffer_load_dwordx4 v1, s[4:7], s49 offen offset:2048 sc1 lds
  ds_read_b128 v[120:123], v3 offset:6144
  s_waitcnt lgkmcnt(6)
  v_mfma_f32_32x32x16_bf16 v[32:47], v[96:99], a[0:3], 0
  buffer_load_dwordx4 v1, s[4:7], s49 offen offset:3072 sc1 lds
  ds_read_b128 v[124:127], v3 offset:7168
  s_waitcnt lgkmcnt(6)
  v_mfma_f32_32x32x16_bf16 v[32:47], v[100:103], a[4:7], v[32:47]
  s_nop 3
  v_mul_f32 v80, v80, v19
  v_mul_f32 v80, v80, v88
  v_mul_f32 v81, v81, v19
  ds_read_b128 v[96:99], v3 offset:8192
  s_waitcnt lgkmcnt(6)
  v_mfma_f32_32x32x16_bf16 v[32:47], v[104:107], a[8:11], v[32:47]
  s_cbranch_vccnz L_main_skip_55
  s_add_u32 s47, s30, 6021120
  buffer_load_dwordx4 a[224:227], v1, s[4:7], s47 offen sc1
  s_add_u32 s48, s31, 6021120
  buffer_load_dwordx4 a[228:231], v1, s[4:7], s48 offen sc1
  s_add_u32 s47, s30, 6021120
  buffer_load_dwordx4 a[232:235], v1, s[4:7], s47 offen offset:1024 sc1
  s_add_u32 s48, s31, 6021120
  buffer_load_dwordx4 a[236:239], v1, s[4:7], s48 offen offset:1024 sc1
L_main_skip_55:
  v_mul_f32 v81, v81, v89
  v_cvt_pk_bf16_f32 v88, v80, v81
  v_mul_f32 v82, v82, v19
  ds_read_b128 v[100:103], v3 offset:9216
  s_waitcnt lgkmcnt(6)
  v_mfma_f32_32x32x16_bf16 v[32:47], v[108:111], a[12:15], v[32:47]
  v_mul_f32 v82, v82, v90
  v_mul_f32 v83, v83, v19
  v_mul_f32 v83, v83, v91
  ds_read_b128 v[104:107], v3 offset:10240
  s_waitcnt lgkmcnt(6)
  v_mfma_f32_32x32x16_bf16 v[32:47], v[112:115], a[16:19], v[32:47]
  v_cvt_pk_bf16_f32 v89, v82, v83
  v_mul_f32 v84, v84, v19
  v_mul_f32 v84, v84, v92
  ds_read_b128 v[108:111], v3 offset:11264
  s_waitcnt lgkmcnt(6)
  v_mfma_f32_32x32x16_bf16 v[32:47], v[116:119], a[20:23], v[32:47]
  v_mul_f32 v85, v85, v19
  v_mul_f32 v85, v85, v93
  v_cvt_pk_bf16_f32 v90, v84, v85
  ds_read_b128 v[112:115], v3 offset:12288
  s_waitcnt lgkmcnt(6)
  v_mfma_f32_32x32x16_bf16 v[32:47], v[120:123], a[24:27], v[32:47]
  v_mul_f32 v86, v86, v19
  v_mul_f32 v86, v86, v94
  v_mul_f32 v87, v87, v19
  ds_read_b128 v[116:119], v3 offset:13312
  s_waitcnt lgkmcnt(6)
  v_mfma_f32_32x32x16_bf16 v[32:47], v[124:127], a[28:31], v[32:47]
  s_cbranch_vccnz L_main_skip_56
  s_add_u32 s47, s30, 6021120
  buffer_load_dwordx4 a[240:243], v1, s[4:7], s47 offen offset:2048 sc1
  s_add_u32 s48, s31, 6021120
  buffer_load_dwordx4 a[244:247], v1, s[4:7], s48 offen offset:2048 sc1
  s_add_u32 s47, s30, 6025216
  buffer_load_dwordx4 a[248:251], v1, s[4:7], s47 offen offset:1024 sc1
  s_add_u32 s48, s31, 6025216
  buffer_load_dwordx4 a[252:255], v1, s[4:7], s48 offen offset:1024 sc1
L_main_skip_56:
  v_mul_f32 v87, v87, v95
  v_cvt_pk_bf16_f32 v91, v86, v87
  s_add_u32 s63, s23, 31457280
  buffer_store_dwordx4 v[88:91], v1, s[4:7], s63 offen offset:3072 sc1
  ds_read_b128 v[120:123], v3 offset:14336
  s_waitcnt lgkmcnt(6)
  v_mfma_f32_32x32x16_bf16 v[32:47], v[96:99], a[32:35], v[32:47]
  ds_read_b128 v[124:127], v3 offset:15360
  s_waitcnt lgkmcnt(6)
  v_mfma_f32_32x32x16_bf16 v[32:47], v[100:103], a[36:39], v[32:47]
  s_waitcnt vmcnt(28)
  s_cbranch_vccz L_main_w_115
  s_waitcnt vmcnt(12)
L_main_w_115:
  s_barrier
  ds_read_b128 v[96:99], v3 offset:16384
  s_waitcnt lgkmcnt(6)
  v_mfma_f32_32x32x16_bf16 v[32:47], v[104:107], a[40:43], v[32:47]
  ds_read_b128 v[100:103], v3 offset:17408
  s_waitcnt lgkmcnt(6)
  v_mfma_f32_32x32x16_bf16 v[32:47], v[108:111], a[44:47], v[32:47]
  ds_read_b128 v[104:107], v3 offset:18432
  s_waitcnt lgkmcnt(6)
  v_mfma_f32_32x32x16_bf16 v[32:47], v[112:115], a[48:51], v[32:47]
  s_add_u32 s49, s19, 2416640
  s_add_u32 m0, s15, 114688
  s_nop 0
  buffer_load_dwordx4 v1, s[4:7], s49 offen sc1 lds
  ds_read_b128 v[108:111], v3 offset:19456
  s_waitcnt lgkmcnt(6)
  v_mfma_f32_32x32x16_bf16 v[32:47], v[116:119], a[52:55], v[32:47]
  buffer_load_dwordx4 v1, s[4:7], s49 offen offset:1024 sc1 lds
  ds_read_b128 v[112:115], v3 offset:20480
  s_waitcnt lgkmcnt(6)
  v_mfma_f32_32x32x16_bf16 v[32:47], v[120:123], a[56:59], v[32:47]
  ds_read_b128 v[116:119], v3 offset:21504
  s_waitcnt lgkmcnt(6)
  v_mfma_f32_32x32x16_bf16 v[32:47], v[124:127], a[60:63], v[32:47]
  buffer_load_dwordx4 v1, s[4:7], s49 offen offset:2048 sc1 lds
  ds_read_b128 v[120:123], v3 offset:22528
  s_waitcnt lgkmcnt(6)
  v_mfma_f32_32x32x16_bf16 v[32:47], v[96:99], a[64:67], v[32:47]
  buffer_load_dwordx4 v1, s[4:7], s49 offen offset:3072 sc1 lds
  ds_read_b128 v[124:127], v3 offset:23552
  s_waitcnt lgkmcnt(6)
  v_mfma_f32_32x32x16_bf16 v[32:47], v[100:103], a[68:71], v[32:47]
  ds_read_b128 v[96:99], v3 offset:24576
  s_waitcnt lgkmcnt(6)
  v_mfma_f32_32x32x16_bf16 v[32:47], v[104:107], a[72:75], v[32:47]
  s_cbranch_vccnz L_main_skip_57
  s_add_u32 s47, s30, 6025216
  buffer_load_dwordx4 v[160:163], v1, s[4:7], s47 offen offset:2048 sc1
  s_add_u32 s48, s31, 6025216
  buffer_load_dwordx4 v[164:167], v1, s[4:7], s48 offen offset:2048 sc1
  s_add_u32 s47, s30, 6025216
  buffer_load_dwordx4 v[168:171], v1, s[4:7], s47 offen offset:3072 sc1
  s_add_u32 s48, s31, 6025216
  buffer_load_dwordx4 v[172:175], v1, s[4:7], s48 offen offset:3072 sc1
L_main_skip_57:
  ds_read_b128 v[100:103], v3 offset:25600
  s_waitcnt lgkmcnt(6)
  v_mfma_f32_32x32x16_bf16 v[32:47], v[108:111], a[76:79], v[32:47]
  ds_read_b128 v[104:107], v3 offset:26624
  s_waitcnt lgkmcnt(6)
  v_mfma_f32_32x32x16_bf16 v[32:47], v[112:115], a[80:83], v[32:47]
  ds_read_b128 v[108:111], v3 offset:27648
  s_waitcnt lgkmcnt(6)
  v_mfma_f32_32x32x16_bf16 v[32:47], v[116:119], a[84:87], v[32:47]
  ds_read_b128 v[112:115], v3 offset:28672
  s_waitcnt lgkmcnt(6)
  v_mfma_f32_32x32x16_bf16 v[32:47], v[120:123], a[88:91], v[32:47]
  ds_read_b128 v[116:119], v3 offset:29696
  s_waitcnt lgkmcnt(6)
  v_mfma_f32_32x32x16_bf16 v[32:47], v[124:127], a[92:95], v[32:47]
  s_cbranch_vccnz L_main_skip_58
  s_add_u32 s47, s30, 6029312
  buffer_load_dwordx4 v[176:179], v1, s[4:7], s47 offen sc1
  s_add_u32 s48, s31, 6029312
  buffer_load_dwordx4 v[180:183], v1, s[4:7], s48 offen sc1
  s_add_u32 s47, s30, 6029312
  buffer_load_dwordx4 v[184:187], v1, s[4:7], s47 offen offset:1024 sc1
  s_add_u32 s48, s31, 6029312
  buffer_load_dwordx4 v[188:191], v1, s[4:7], s48 offen offset:1024 sc1
L_main_skip_58:
  ds_read_b128 v[120:123], v3 offset:30720
  s_waitcnt lgkmcnt(6)
  v_mfma_f32_32x32x16_bf16 v[32:47], v[96:99], a[96:99], v[32:47]
  ds_read_b128 v[124:127], v3 offset:31744
  s_waitcnt lgkmcnt(6)
  v_mfma_f32_32x32x16_bf16 v[32:47], v[100:103], a[100:103], v[32:47]
  s_waitcnt vmcnt(35)
  s_cbranch_vccz L_main_w_116
  s_waitcnt vmcnt(11)
L_main_w_116:
  s_barrier
  ds_read_b128 v[96:99], v2 offset:16384
  s_waitcnt lgkmcnt(6)
  v_mfma_f32_32x32x16_bf16 v[32:47], v[104:107], a[104:107], v[32:47]
  ds_read_b128 v[100:103], v2 offset:17408
  s_waitcnt lgkmcnt(6)
  v_mfma_f32_32x32x16_bf16 v[32:47], v[108:111], a[108:111], v[32:47]
  ds_read_b128 v[104:107], v2 offset:18432
  s_waitcnt lgkmcnt(6)
  v_mfma_f32_32x32x16_bf16 v[32:47], v[112:115], a[112:115], v[32:47]
  ds_read_b128 v[108:111], v2 offset:19456
  s_waitcnt lgkmcnt(6)
  v_mfma_f32_32x32x16_bf16 v[32:47], v[116:119], a[116:119], v[32:47]
  s_add_u32 s49, s19, 2433024
  s_add_u32 m0, s15, 131072
  s_nop 0
  buffer_load_dwordx4 v1, s[4:7], s49 offen sc1 lds
  ds_read_b128 v[112:115], v2 offset:20480
  s_waitcnt lgkmcnt(6)
  v_mfma_f32_32x32x16_bf16 v[32:47], v[120:123], a[120:123], v[32:47]
  buffer_load_dwordx4 v1, s[4:7], s49 offen offset:1024 sc1 lds
  ds_read_b128 v[116:119], v2 offset:21504
  s_waitcnt lgkmcnt(6)
  v_mfma_f32_32x32x16_bf16 v[32:47], v[124:127], a[124:127], v[32:47]
  buffer_load_dwordx4 v1, s[4:7], s49 offen offset:2048 sc1 lds
  v_mfma_f32_32x32x16_bf16 v[32:47], v[148:151], v[20:23], v[32:47]
  ds_read_b128 v[120:123], v2 offset:22528
  s_waitcnt lgkmcnt(6)
  v_mfma_f32_32x32x16_bf16 v[48:63], v[96:99], a[0:3], 0
  buffer_load_dwordx4 v1, s[4:7], s49 offen offset:3072 sc1 lds
  ds_read_b128 v[124:127], v2 offset:23552
  s_waitcnt lgkmcnt(6)
  v_mfma_f32_32x32x16_bf16 v[48:63], v[100:103], a[4:7], v[48:63]
  s_cbranch_vccnz L_main_skip_69
L_main_skip_69:
  s_nop 3
  v_mul_f32 v32, v32, v19
  v_mul_f32 v32, v32, v40
  v_mul_f32 v33, v33, v19
  ds_read_b128 v[96:99], v2 offset:24576
  s_waitcnt lgkmcnt(6)
  v_mfma_f32_32x32x16_bf16 v[48:63], v[104:107], a[8:11], v[48:63]
  s_cbranch_vccnz L_main_skip_59
  s_add_u32 s47, s30, 6008832
  buffer_load_dwordx4 v[192:195], v1, s[4:7], s47 offen offset:1024 sc1
  s_add_u32 s48, s31, 6008832
  buffer_load_dwordx4 v[196:199], v1, s[4:7], s48 offen offset:1024 sc1
  s_add_u32 s47, s30, 6008832
  buffer_load_dwordx4 v[200:203], v1, s[4:7], s47 offen offset:2048 sc1
  s_add_u32 s48, s31, 6008832
  buffer_load_dwordx4 v[204:207], v1, s[4:7], s48 offen offset:2048 sc1
L_main_skip_59:
  v_mul_f32 v33, v33, v41
  v_cvt_pk_bf16_f32 v40, v32, v33
  v_mul_f32 v34, v34, v19
  ds_read_b128 v[100:103], v2 offset:25600
  s_waitcnt lgkmcnt(6)
  v_mfma_f32_32x32x16_bf16 v[48:63], v[108:111], a[12:15], v[48:63]
  v_mul_f32 v34, v34, v42
  v_mul_f32 v35, v35, v19
  v_mul_f32 v35, v35, v43
  ds_read_b128 v[104:107], v2 offset:26624
  s_waitcnt lgkmcnt(6)
  v_mfma_f32_32x32x16_bf16 v[48:63], v[112:115], a[16:19], v[48:63]
  v_cvt_pk_bf16_f32 v41, v34, v35
  v_mul_f32 v36, v36, v19
  v_mul_f32 v36, v36, v44
  ds_read_b128 v[108:111], v2 offset:27648
  s_waitcnt lgkmcnt(6)
  v_mfma_f32_32x32x16_bf16 v[48:63], v[116:119], a[20:23], v[48:63]
  v_mul_f32 v37, v37, v19
  v_mul_f32 v37, v37, v45
  v_cvt_pk_bf16_f32 v42, v36, v37
  ds_read_b128 v[112:115], v2 offset:28672
  s_waitcnt lgkmcnt(6)
  v_mfma_f32_32x32x16_bf16 v[48:63], v[120:123], a[24:27], v[48:63]
  v_mul_f32 v38, v38, v19
  v_mul_f32 v38, v38, v46
  v_mul_f32 v39, v39, v19
  ds_read_b128 v[116:119], v2 offset:29696
  s_waitcnt lgkmcnt(6)
  v_mfma_f32_32x32x16_bf16 v[48:63], v[124:127], a[28:31], v[48:63]
  v_mul_f32 v39, v39, v47
  v_cvt_pk_bf16_f32 v43, v38, v39
  s_add_u32 s63, s23, 31461376
  buffer_store_dwordx4 v[40:43], v1, s[4:7], s63 offen sc1
  ds_read_b128 v[120:123], v2 offset:30720
  s_waitcnt lgkmcnt(6)
  v_mfma_f32_32x32x16_bf16 v[48:63], v[96:99], a[32:35], v[48:63]
  ds_read_b128 v[124:127], v2 offset:31744
  s_waitcnt lgkmcnt(6)
  v_mfma_f32_32x32x16_bf16 v[48:63], v[100:103], a[36:39], v[48:63]
  s_waitcnt vmcnt(30)
  s_cbranch_vccz L_main_w_117
  s_waitcnt vmcnt(10)
L_main_w_117:
  s_barrier
  ds_read_b128 v[96:99], v2 offset:32768
  s_waitcnt lgkmcnt(6)
  v_mfma_f32_32x32x16_bf16 v[48:63], v[104:107], a[40:43], v[48:63]
  s_cbranch_vccnz L_main_skip_60
  s_add_u32 s47, s30, 6017024
  buffer_load_dwordx4 v[208:211], v1, s[4:7], s47 offen sc1
  s_add_u32 s48, s31, 6017024
  buffer_load_dwordx4 v[212:215], v1, s[4:7], s48 offen sc1
  s_add_u32 s47, s30, 6017024
  buffer_load_dwordx4 v[216:219], v1, s[4:7], s47 offen offset:1024 sc1
  s_add_u32 s48, s31, 6017024
  buffer_load_dwordx4 v[220:223], v1, s[4:7], s48 offen offset:1024 sc1
L_main_skip_60:
  ds_read_b128 v[100:103], v2 offset:33792
  s_waitcnt lgkmcnt(6)
  v_mfma_f32_32x32x16_bf16 v[48:63], v[108:111], a[44:47], v[48:63]
  ds_read_b128 v[104:107], v2 offset:34816
  s_waitcnt lgkmcnt(6)
  v_mfma_f32_32x32x16_bf16 v[48:63], v[112:115], a[48:51], v[48:63]
  ds_read_b128 v[108:111], v2 offset:35840
  s_waitcnt lgkmcnt(6)
  v_mfma_f32_32x32x16_bf16 v[48:63], v[116:119], a[52:55], v[48:63]
  ds_read_b128 v[112:115], v2 offset:36864
  s_waitcnt lgkmcnt(6)
  v_mfma_f32_32x32x16_bf16 v[48:63], v[120:123], a[56:59], v[48:63]
  ds_read_b128 v[116:119], v2 offset:37888
  s_waitcnt lgkmcnt(6)
  v_mfma_f32_32x32x16_bf16 v[48:63], v[124:127], a[60:63], v[48:63]
  ds_read_b128 v[120:123], v2 offset:38912
  s_waitcnt lgkmcnt(6)
  v_mfma_f32_32x32x16_bf16 v[48:63], v[96:99], a[64:67], v[48:63]
  ds_read_b128 v[124:127], v2 offset:39936
  s_waitcnt lgkmcnt(6)
  v_mfma_f32_32x32x16_bf16 v[48:63], v[100:103], a[68:71], v[48:63]
  ds_read_b128 v[96:99], v2 offset:40960
  s_waitcnt lgkmcnt(6)
  v_mfma_f32_32x32x16_bf16 v[48:63], v[104:107], a[72:75], v[48:63]
  ds_read_b128 v[100:103], v2 offset:41984
  s_waitcnt lgkmcnt(6)
  v_mfma_f32_32x32x16_bf16 v[48:63], v[108:111], a[76:79], v[48:63]
  s_cbranch_vccnz L_main_skip_61
  s_add_u32 s47, s30, 6021120
  buffer_load_dwordx4 v[224:227], v1, s[4:7], s47 offen offset:3072 sc1
  s_add_u32 s48, s31, 6021120
  buffer_load_dwordx4 v[228:231], v1, s[4:7], s48 offen offset:3072 sc1
  s_add_u32 s47, s30, 6025216
  buffer_load_dwordx4 v[232:235], v1, s[4:7], s47 offen sc1
  s_add_u32 s48, s31, 6025216
  buffer_load_dwordx4 v[236:239], v1, s[4:7], s48 offen sc1
L_main_skip_61:
  ds_read_b128 v[104:107], v2 offset:43008
  s_waitcnt lgkmcnt(6)
  v_mfma_f32_32x32x16_bf16 v[48:63], v[112:115], a[80:83], v[48:63]
  ds_read_b128 v[108:111], v2 offset:44032
  s_waitcnt lgkmcnt(6)
  v_mfma_f32_32x32x16_bf16 v[48:63], v[116:119], a[84:87], v[48:63]
  ds_read_b128 v[112:115], v2 offset:45056
  s_waitcnt lgkmcnt(6)
  v_mfma_f32_32x32x16_bf16 v[48:63], v[120:123], a[88:91], v[48:63]
  ds_read_b128 v[116:119], v2 offset:46080
  s_waitcnt lgkmcnt(6)
  v_mfma_f32_32x32x16_bf16 v[48:63], v[124:127], a[92:95], v[48:63]
  ds_read_b128 v[120:123], v2 offset:47104
  s_waitcnt lgkmcnt(6)
  v_mfma_f32_32x32x16_bf16 v[48:63], v[96:99], a[96:99], v[48:63]
  ds_read_b128 v[124:127], v2 offset:48128
  s_waitcnt lgkmcnt(6)
  v_mfma_f32_32x32x16_bf16 v[48:63], v[100:103], a[100:103], v[48:63]
  s_waitcnt vmcnt(25)
  s_cbranch_vccz L_main_w_118
  s_waitcnt vmcnt(5)
L_main_w_118:
  s_barrier
  ds_read_b128 v[96:99], v2 offset:49152
  s_waitcnt lgkmcnt(6)
  v_mfma_f32_32x32x16_bf16 v[48:63], v[104:107], a[104:107], v[48:63]
  ds_read_b128 v[100:103], v2 offset:50176
  s_waitcnt lgkmcnt(6)
  v_mfma_f32_32x32x16_bf16 v[48:63], v[108:111], a[108:111], v[48:63]
  s_add_u32 s64, s77, 2
  v_mov_b32 v29, s64
  s_waitcnt vmcnt(8)
  s_cbranch_vccz L_main_w_119
  s_waitcnt vmcnt(0)
L_main_w_119:
  s_mov_b64 exec, 1
  s_cmp_eq_u32 s76, 0
  s_cbranch_scc1 L_main_pslow_63
  buffer_store_dword v29, off, s[4:7], s100
L_main_pdone_64:
  s_mov_b64 exec, -1
  ds_read_b128 v[104:107], v2 offset:51200
  s_waitcnt lgkmcnt(6)
  v_mfma_f32_32x32x16_bf16 v[48:63], v[112:115], a[112:115], v[48:63]
  s_cbranch_vccnz L_main_skip_62
  s_add_u32 s47, s30, 6029312
  buffer_load_dwordx4 v[240:243], v1, s[4:7], s47 offen offset:2048 sc1
  s_add_u32 s48, s31, 6029312
  buffer_load_dwordx4 v[244:247], v1, s[4:7], s48 offen offset:2048 sc1
  s_add_u32 s47, s30, 6029312
  buffer_load_dwordx4 v[248:251], v1, s[4:7], s47 offen offset:3072 sc1
  s_add_u32 s48, s31, 6029312
  buffer_load_dwordx4 v[252:255], v1, s[4:7], s48 offen offset:3072 sc1
L_main_skip_62:
  ds_read_b128 v[108:111], v2 offset:52224
  s_waitcnt lgkmcnt(6)
  v_mfma_f32_32x32x16_bf16 v[48:63], v[116:119], a[116:119], v[48:63]
  ds_read_b128 v[112:115], v2 offset:53248
  s_waitcnt lgkmcnt(6)
  v_mfma_f32_32x32x16_bf16 v[48:63], v[120:123], a[120:123], v[48:63]
  ds_read_b128 v[116:119], v2 offset:54272
  s_waitcnt lgkmcnt(6)
  v_mfma_f32_32x32x16_bf16 v[48:63], v[124:127], a[124:127], v[48:63]
  v_mfma_f32_32x32x16_bf16 v[48:63], v[152:155], v[20:23], v[48:63]
  ds_read_b128 v[120:123], v2 offset:55296
  s_waitcnt lgkmcnt(6)
  v_mfma_f32_32x32x16_bf16 v[64:79], v[96:99], a[0:3], 0
  ds_read_b128 v[124:127], v2 offset:56320
  s_waitcnt lgkmcnt(6)
  v_mfma_f32_32x32x16_bf16 v[64:79], v[100:103], a[4:7], v[64:79]
  s_nop 5
  v_mul_f32 v48, v48, v19
  v_mul_f32 v48, v48, v56
  v_mul_f32 v49, v49, v19
  ds_read_b128 v[96:99], v2 offset:57344
  s_waitcnt lgkmcnt(6)
  v_mfma_f32_32x32x16_bf16 v[64:79], v[104:107], a[8:11], v[64:79]
  v_mul_f32 v49, v49, v57
  v_cvt_pk_bf16_f32 v56, v48, v49
  v_mul_f32 v50, v50, v19
  ds_read_b128 v[100:103], v2 offset:58368
  s_waitcnt lgkmcnt(6)
  v_mfma_f32_32x32x16_bf16 v[64:79], v[108:111], a[12:15], v[64:79]
  v_mul_f32 v50, v50, v58
  v_mul_f32 v51, v51, v19
  v_mul_f32 v51, v51, v59
  ds_read_b128 v[104:107], v2 offset:59392
  s_waitcnt lgkmcnt(6)
  v_mfma_f32_32x32x16_bf16 v[64:79], v[112:115], a[16:19], v[64:79]
  v_cvt_pk_bf16_f32 v57, v50, v51
  v_mul_f32 v52, v52, v19
  v_mul_f32 v52, v52, v60
  s_add_u32 s46, s32, 24641536
  buffer_load_dwordx4 v[136:139], v1, s[4:7], s46 offen sc1
  buffer_load_dword v30, v9, s[4:7], 0 offen sc1
  ds_read_b128 v[108:111], v2 offset:60416
  s_waitcnt lgkmcnt(6)
  v_mfma_f32_32x32x16_bf16 v[64:79], v[116:119], a[20:23], v[64:79]
  v_mul_f32 v53, v53, v19
  v_mul_f32 v53, v53, v61
  v_cvt_pk_bf16_f32 v58, v52, v53
  buffer_load_dwordx4 v[140:143], v1, s[4:7], s46 offen offset:1024 sc1
  ds_read_b128 v[112:115], v2 offset:61440
  s_waitcnt lgkmcnt(6)
  v_mfma_f32_32x32x16_bf16 v[64:79], v[120:123], a[24:27], v[64:79]
  v_mul_f32 v54, v54, v19
  v_mul_f32 v54, v54, v62
  v_mul_f32 v55, v55, v19
  ds_read_b128 v[116:119], v2 offset:62464
  s_waitcnt lgkmcnt(6)
  v_mfma_f32_32x32x16_bf16 v[64:79], v[124:127], a[28:31], v[64:79]
  v_mul_f32 v55, v55, v63
  v_cvt_pk_bf16_f32 v59, v54, v55
  s_add_u32 s63, s23, 31461376
  buffer_store_dwordx4 v[56:59], v1, s[4:7], s63 offen offset:1024 sc1
  ds_read_b128 v[120:123], v2 offset:63488
  s_waitcnt lgkmcnt(6)
  v_mfma_f32_32x32x16_bf16 v[64:79], v[96:99], a[32:35], v[64:79]
  ds_read_b128 v[124:127], v2 offset:64512
  s_waitcnt lgkmcnt(6)
  v_mfma_f32_32x32x16_bf16 v[64:79], v[100:103], a[36:39], v[64:79]
  s_barrier
  ds_read_b128 v[96:99], v3
  s_waitcnt lgkmcnt(6)
  v_mfma_f32_32x32x16_bf16 v[64:79], v[104:107], a[40:43], v[64:79]
  ds_read_b128 v[100:103], v3 offset:1024
  s_waitcnt lgkmcnt(6)
  v_mfma_f32_32x32x16_bf16 v[64:79], v[108:111], a[44:47], v[64:79]
  ds_read_b128 v[104:107], v3 offset:2048
  s_waitcnt lgkmcnt(6)
  v_mfma_f32_32x32x16_bf16 v[64:79], v[112:115], a[48:51], v[64:79]
  ds_read_b128 v[108:111], v3 offset:3072
  s_waitcnt lgkmcnt(6)
  v_mfma_f32_32x32x16_bf16 v[64:79], v[116:119], a[52:55], v[64:79]
  ds_read_b128 v[112:115], v3 offset:4096
  s_waitcnt lgkmcnt(6)
  v_mfma_f32_32x32x16_bf16 v[64:79], v[120:123], a[56:59], v[64:79]
  s_add_u32 s62, s77, 2
  s_mov_b32 s63, 0
  s_waitcnt vmcnt(2)
  v_cmp_gt_u32 s[64:65], s62, v30
  s_nop 3
  s_cmp_lg_u64 s[64:65], 0
  s_cbranch_scc1 L_main_floop_65
L_main_finv_67:
L_main_fdone_66:
  ds_read_b128 v[116:119], v3 offset:5120
  s_waitcnt lgkmcnt(6)
  v_mfma_f32_32x32x16_bf16 v[64:79], v[124:127], a[60:63], v[64:79]
  s_add_u32 s44, s28, 31457280
  buffer_load_dwordx4 a[0:3], v1, s[4:7], s44 offen sc1
  ds_read_b128 v[120:123], v3 offset:6144
  s_waitcnt lgkmcnt(6)
  v_mfma_f32_32x32x16_bf16 v[64:79], v[96:99], a[64:67], v[64:79]
  s_add_u32 s45, s29, 31457280
  buffer_load_dwordx4 a[4:7], v1, s[4:7], s45 offen sc1
  ds_read_b128 v[124:127], v3 offset:7168
  s_waitcnt lgkmcnt(6)
  v_mfma_f32_32x32x16_bf16 v[64:79], v[100:103], a[68:71], v[64:79]
  s_add_u32 s44, s28, 31457280
  buffer_load_dwordx4 a[8:11], v1, s[4:7], s44 offen offset:1024 sc1
  ds_read_b128 v[96:99], v3 offset:8192
  s_waitcnt lgkmcnt(6)
  v_mfma_f32_32x32x16_bf16 v[64:79], v[104:107], a[72:75], v[64:79]
  s_add_u32 s45, s29, 31457280
  buffer_load_dwordx4 a[12:15], v1, s[4:7], s45 offen offset:1024 sc1
  ds_read_b128 v[100:103], v3 offset:9216
  s_waitcnt lgkmcnt(6)
  v_mfma_f32_32x32x16_bf16 v[64:79], v[108:111], a[76:79], v[64:79]
  ds_read_b128 v[104:107], v3 offset:10240
  s_waitcnt lgkmcnt(6)
  v_mfma_f32_32x32x16_bf16 v[64:79], v[112:115], a[80:83], v[64:79]
  s_add_u32 s44, s28, 31457280
  buffer_load_dwordx4 a[16:19], v1, s[4:7], s44 offen offset:2048 sc1
  ds_read_b128 v[108:111], v3 offset:11264
  s_waitcnt lgkmcnt(6)
  v_mfma_f32_32x32x16_bf16 v[64:79], v[116:119], a[84:87], v[64:79]
  s_add_u32 s45, s29, 31457280
  buffer_load_dwordx4 a[20:23], v1, s[4:7], s45 offen offset:2048 sc1
  ds_read_b128 v[112:115], v3 offset:12288
  s_waitcnt lgkmcnt(6)
  v_mfma_f32_32x32x16_bf16 v[64:79], v[120:123], a[88:91], v[64:79]
  s_add_u32 s44, s28, 31457280
  buffer_load_dwordx4 a[24:27], v1, s[4:7], s44 offen offset:3072 sc1
  ds_read_b128 v[116:119], v3 offset:13312
  s_waitcnt lgkmcnt(6)
  v_mfma_f32_32x32x16_bf16 v[64:79], v[124:127], a[92:95], v[64:79]
  ds_read_b128 v[120:123], v3 offset:14336
  s_waitcnt lgkmcnt(6)
  v_mfma_f32_32x32x16_bf16 v[64:79], v[96:99], a[96:99], v[64:79]
  s_add_u32 s45, s29, 31457280
  buffer_load_dwordx4 a[28:31], v1, s[4:7], s45 offen offset:3072 sc1
  ds_read_b128 v[124:127], v3 offset:15360
  s_waitcnt lgkmcnt(6)
  v_mfma_f32_32x32x16_bf16 v[64:79], v[100:103], a[100:103], v[64:79]
  s_add_u32 s44, s28, 31461376
  buffer_load_dwordx4 a[32:35], v1, s[4:7], s44 offen sc1
  s_waitcnt lgkmcnt(5)
  v_mfma_f32_32x32x16_bf16 v[64:79], v[104:107], a[104:107], v[64:79]
  s_add_u32 s45, s29, 31461376
  buffer_load_dwordx4 a[36:39], v1, s[4:7], s45 offen sc1
  s_waitcnt lgkmcnt(4)
  v_mfma_f32_32x32x16_bf16 v[64:79], v[108:111], a[108:111], v[64:79]
  s_add_u32 s44, s28, 31461376
  buffer_load_dwordx4 a[40:43], v1, s[4:7], s44 offen offset:3072 sc1
  s_waitcnt lgkmcnt(3)
  v_mfma_f32_32x32x16_bf16 v[64:79], v[112:115], a[112:115], v[64:79]
  s_waitcnt lgkmcnt(2)
  v_mfma_f32_32x32x16_bf16 v[64:79], v[116:119], a[116:119], v[64:79]
  s_add_u32 s45, s29, 31461376
  buffer_load_dwordx4 a[44:47], v1, s[4:7], s45 offen offset:3072 sc1
  s_waitcnt lgkmcnt(1)
  v_mfma_f32_32x32x16_bf16 v[64:79], v[120:123], a[120:123], v[64:79]
  s_add_u32 s44, s28, 31465472
  buffer_load_dwordx4 a[48:51], v1, s[4:7], s44 offen sc1
  s_waitcnt lgkmcnt(0)
  v_mfma_f32_32x32x16_bf16 v[64:79], v[124:127], a[124:127], v[64:79]
  s_add_u32 s45, s29, 31465472
  buffer_load_dwordx4 a[52:55], v1, s[4:7], s45 offen sc1
  v_mfma_f32_32x32x16_bf16 v[64:79], v[156:159], v[20:23], v[64:79]
  s_nop 11
  v_mul_f32 v64, v64, v19
  v_mul_f32 v64, v64, v72
  v_mul_f32 v65, v65, v19
  v_mul_f32 v65, v65, v73
  v_cvt_pk_bf16_f32 v72, v64, v65
  v_mul_f32 v66, v66, v19
  v_mul_f32 v66, v66, v74
  v_mul_f32 v67, v67, v19
  v_mul_f32 v67, v67, v75
  v_cvt_pk_bf16_f32 v73, v66, v67
  v_mul_f32 v68, v68, v19
  v_mul_f32 v68, v68, v76
  v_mul_f32 v69, v69, v19
  v_mul_f32 v69, v69, v77
  v_cvt_pk_bf16_f32 v74, v68, v69
  v_mul_f32 v70, v70, v19
  v_mul_f32 v70, v70, v78
  v_mul_f32 v71, v71, v19
  v_mul_f32 v71, v71, v79
  v_cvt_pk_bf16_f32 v75, v70, v71
  s_add_u32 s63, s23, 31461376
  buffer_store_dwordx4 v[72:75], v1, s[4:7], s63 offen offset:2048 sc1
  s_add_u32 s44, s28, 31465472
  buffer_load_dwordx4 a[56:59], v1, s[4:7], s44 offen offset:1024 sc1
  s_add_u32 s45, s29, 31465472
  buffer_load_dwordx4 a[60:63], v1, s[4:7], s45 offen offset:1024 sc1
  v_lshlrev_b32 v32, 16, v136
  v_and_b32 v33, 0xffff0000, v136
  v_lshlrev_b32 v34, 16, v137
  v_and_b32 v35, 0xffff0000, v137
  v_lshlrev_b32 v36, 16, v138
  v_and_b32 v37, 0xffff0000, v138
  v_lshlrev_b32 v38, 16, v139
  v_and_b32 v39, 0xffff0000, v139
  s_waitcnt vmcnt(18)
  v_lshlrev_b32 v40, 16, v140
  v_and_b32 v41, 0xffff0000, v140
  v_lshlrev_b32 v42, 16, v141
  v_and_b32 v43, 0xffff0000, v141
  v_lshlrev_b32 v44, 16, v142
  v_and_b32 v45, 0xffff0000, v142
  v_lshlrev_b32 v46, 16, v143
  v_and_b32 v47, 0xffff0000, v143
  s_waitcnt vmcnt(16)
  s_nop 0
  v_mfma_f32_32x32x16_bf16 v[32:47], a[128:131], a[0:3], v[32:47]
  s_add_u32 s44, s28, 31465472
  buffer_load_dwordx4 a[64:67], v1, s[4:7], s44 offen offset:2048 sc1
  v_mfma_f32_32x32x16_bf16 v[48:63], a[132:135], a[0:3], 0
  s_waitcnt vmcnt(16)
  v_mfma_f32_32x32x16_bf16 v[64:79], a[128:131], a[4:7], 0
  s_add_u32 s45, s29, 31465472
  buffer_load_dwordx4 a[68:71], v1, s[4:7], s45 offen offset:2048 sc1
  v_mfma_f32_32x32x16_bf16 v[80:95], a[132:135], a[4:7], 0
  s_waitcnt vmcnt(16)
  v_mfma_f32_32x32x16_bf16 v[32:47], a[136:139], a[8:11], v[32:47]
  s_add_u32 s44, s28, 31465472
  buffer_load_dwordx4 a[72:75], v1, s[4:7], s44 offen offset:3072 sc1
  v_mfma_f32_32x32x16_bf16 v[48:63], a[140:143], a[8:11], v[48:63]
  s_waitcnt vmcnt(16)
  v_mfma_f32_32x32x16_bf16 v[64:79], a[136:139], a[12:15], v[64:79]
  s_add_u32 s45, s29, 31465472
  buffer_load_dwordx4 a[76:79], v1, s[4:7], s45 offen offset:3072 sc1
  v_mfma_f32_32x32x16_bf16 v[80:95], a[140:143], a[12:15], v[80:95]
  s_waitcnt vmcnt(16)
  v_mfma_f32_32x32x16_bf16 v[32:47], a[144:147], a[16:19], v[32:47]
  s_add_u32 s44, s28, 31469568
  buffer_load_dwordx4 a[80:83], v1, s[4:7], s44 offen offset:2048 sc1
  v_mfma_f32_32x32x16_bf16 v[48:63], a[148:151], a[16:19], v[48:63]
  s_waitcnt vmcnt(16)
  v_mfma_f32_32x32x16_bf16 v[64:79], a[144:147], a[20:23], v[64:79]
  s_add_u32 s45, s29, 31469568
  buffer_load_dwordx4 a[84:87], v1, s[4:7], s45 offen offset:2048 sc1
  s_add_u32 s64, s77, 3
  v_mov_b32 v29, s64
  s_waitcnt vmcnt(8)
  s_mov_b64 exec, 1
  s_cmp_eq_u32 s76, 0
  s_cbranch_scc1 L_main_pslow_70
  buffer_store_dword v29, off, s[4:7], s100
L_main_pdone_71:
  s_mov_b64 exec, -1
  v_mfma_f32_32x32x16_bf16 v[80:95], a[148:151], a[20:23], v[80:95]
  v_mfma_f32_32x32x16_bf16 v[32:47], a[152:155], a[24:27], v[32:47]
  s_add_u32 s44, s28, 31469568
  buffer_load_dwordx4 a[88:91], v1, s[4:7], s44 offen offset:3072 sc1
  v_mfma_f32_32x32x16_bf16 v[48:63], a[156:159], a[24:27], v[48:63]
  v_mfma_f32_32x32x16_bf16 v[64:79], a[152:155], a[28:31], v[64:79]
  s_add_u32 s45, s29, 31469568
  buffer_load_dwordx4 a[92:95], v1, s[4:7], s45 offen offset:3072 sc1
  v_mfma_f32_32x32x16_bf16 v[80:95], a[156:159], a[28:31], v[80:95]
  v_mfma_f32_32x32x16_bf16 v[32:47], a[160:163], a[32:35], v[32:47]
  s_add_u32 s44, s28, 31473664
  buffer_load_dwordx4 a[96:99], v1, s[4:7], s44 offen sc1
  v_mfma_f32_32x32x16_bf16 v[48:63], a[164:167], a[32:35], v[48:63]
  v_mfma_f32_32x32x16_bf16 v[64:79], a[160:163], a[36:39], v[64:79]
  s_add_u32 s45, s29, 31473664
  buffer_load_dwordx4 a[100:103], v1, s[4:7], s45 offen sc1
  v_mfma_f32_32x32x16_bf16 v[80:95], a[164:167], a[36:39], v[80:95]
  v_mfma_f32_32x32x16_bf16 v[32:47], a[168:171], a[40:43], v[32:47]
  s_add_u32 s44, s28, 31473664
  buffer_load_dwordx4 a[104:107], v1, s[4:7], s44 offen offset:1024 sc1
  v_mfma_f32_32x32x16_bf16 v[48:63], a[172:175], a[40:43], v[48:63]
  v_mfma_f32_32x32x16_bf16 v[64:79], a[168:171], a[44:47], v[64:79]
  s_add_u32 s45, s29, 31473664
  buffer_load_dwordx4 a[108:111], v1, s[4:7], s45 offen offset:1024 sc1
  v_mfma_f32_32x32x16_bf16 v[80:95], a[172:175], a[44:47], v[80:95]
  v_mfma_f32_32x32x16_bf16 v[32:47], a[176:179], a[48:51], v[32:47]
  s_add_u32 s44, s28, 31473664
  buffer_load_dwordx4 a[112:115], v1, s[4:7], s44 offen offset:2048 sc1
  v_mfma_f32_32x32x16_bf16 v[48:63], a[180:183], a[48:51], v[48:63]
  v_mfma_f32_32x32x16_bf16 v[64:79], a[176:179], a[52:55], v[64:79]
  s_add_u32 s45, s29, 31473664
  buffer_load_dwordx4 a[116:119], v1, s[4:7], s45 offen offset:2048 sc1
  v_mfma_f32_32x32x16_bf16 v[80:95], a[180:183], a[52:55], v[80:95]
  s_waitcnt vmcnt(16)
  v_mfma_f32_32x32x16_bf16 v[32:47], a[184:187], a[56:59], v[32:47]
  s_add_u32 s44, s28, 31477760
  buffer_load_dwordx4 a[120:123], v1, s[4:7], s44 offen offset:1024 sc1
  v_mfma_f32_32x32x16_bf16 v[48:63], a[188:191], a[56:59], v[48:63]
  s_waitcnt vmcnt(16)
  v_mfma_f32_32x32x16_bf16 v[64:79], a[184:187], a[60:63], v[64:79]
  s_add_u32 s45, s29, 31477760
  buffer_load_dwordx4 a[124:127], v1, s[4:7], s45 offen offset:1024 sc1
  v_mfma_f32_32x32x16_bf16 v[80:95], a[188:191], a[60:63], v[80:95]
  s_waitcnt vmcnt(16)
  v_mfma_f32_32x32x16_bf16 v[32:47], a[192:195], a[64:67], v[32:47]
  s_add_u32 s44, s28, 31477760
  buffer_load_dwordx4 a[0:3], v1, s[4:7], s44 offen offset:2048 sc1
  v_mfma_f32_32x32x16_bf16 v[48:63], a[196:199], a[64:67], v[48:63]
  s_waitcnt vmcnt(16)
  v_mfma_f32_32x32x16_bf16 v[64:79], a[192:195], a[68:71], v[64:79]
  s_add_u32 s45, s29, 31477760
  buffer_load_dwordx4 a[4:7], v1, s[4:7], s45 offen offset:2048 sc1
  buffer_load_dword v30, v9, s[4:7], 0 offen sc1
  v_mfma_f32_32x32x16_bf16 v[80:95], a[196:199], a[68:71], v[80:95]
  s_waitcnt vmcnt(17)
  v_mfma_f32_32x32x16_bf16 v[32:47], a[200:203], a[72:75], v[32:47]
  s_add_u32 s44, s28, 31477760
  buffer_load_dwordx4 a[8:11], v1, s[4:7], s44 offen offset:3072 sc1
  v_mfma_f32_32x32x16_bf16 v[48:63], a[204:207], a[72:75], v[48:63]
  s_waitcnt vmcnt(17)
  v_mfma_f32_32x32x16_bf16 v[64:79], a[200:203], a[76:79], v[64:79]
  s_add_u32 s45, s29, 31477760
  buffer_load_dwordx4 a[12:15], v1, s[4:7], s45 offen offset:3072 sc1
  v_mfma_f32_32x32x16_bf16 v[80:95], a[204:207], a[76:79], v[80:95]
  s_waitcnt vmcnt(17)
  v_mfma_f32_32x32x16_bf16 v[32:47], a[208:211], a[80:83], v[32:47]
  s_add_u32 s44, s28, 31481856
  buffer_load_dwordx4 a[16:19], v1, s[4:7], s44 offen sc1
  v_mfma_f32_32x32x16_bf16 v[48:63], a[212:215], a[80:83], v[48:63]
  s_waitcnt vmcnt(17)
  v_mfma_f32_32x32x16_bf16 v[64:79], a[208:211], a[84:87], v[64:79]
  s_add_u32 s45, s29, 31481856
  buffer_load_dwordx4 a[20:23], v1, s[4:7], s45 offen sc1
  v_mfma_f32_32x32x16_bf16 v[80:95], a[212:215], a[84:87], v[80:95]
  s_waitcnt vmcnt(16)
  v_mfma_f32_32x32x16_bf16 v[32:47], a[216:219], a[88:91], v[32:47]
  s_add_u32 s44, s28, 31481856
  buffer_load_dwordx4 a[24:27], v1, s[4:7], s44 offen offset:1024 sc1
  v_mfma_f32_32x32x16_bf16 v[48:63], a[220:223], a[88:91], v[48:63]
  s_waitcnt vmcnt(16)
  v_mfma_f32_32x32x16_bf16 v[64:79], a[216:219], a[92:95], v[64:79]
  s_add_u32 s45, s29, 31481856
  buffer_load_dwordx4 a[28:31], v1, s[4:7], s45 offen offset:1024 sc1
  v_mfma_f32_32x32x16_bf16 v[80:95], a[220:223], a[92:95], v[80:95]
  s_add_u32 s62, s77, 3
  s_mov_b32 s63, 0
  s_waitcnt vmcnt(6)
  v_cmp_gt_u32 s[64:65], s62, v30
  s_nop 3
  s_cmp_lg_u64 s[64:65], 0
  s_cbranch_scc1 L_main_floop_72
L_main_finv_74:
L_main_fdone_73:
  s_barrier
  v_mfma_f32_32x32x16_bf16 v[32:47], a[224:227], a[96:99], v[32:47]
  s_add_u32 s44, s28, 31461376
  buffer_load_dwordx4 a[32:35], v1, s[4:7], s44 offen offset:1024 sc1
  v_mfma_f32_32x32x16_bf16 v[48:63], a[228:231], a[96:99], v[48:63]
  v_mfma_f32_32x32x16_bf16 v[64:79], a[224:227], a[100:103], v[64:79]
  s_add_u32 s45, s29, 31461376
  buffer_load_dwordx4 a[36:39], v1, s[4:7], s45 offen offset:1024 sc1
  v_mfma_f32_32x32x16_bf16 v[80:95], a[228:231], a[100:103], v[80:95]
  v_mfma_f32_32x32x16_bf16 v[32:47], a[232:235], a[104:107], v[32:47]
  s_add_u32 s44, s28, 31461376
  buffer_load_dwordx4 a[40:43], v1, s[4:7], s44 offen offset:2048 sc1
  v_mfma_f32_32x32x16_bf16 v[48:63], a[236:239], a[104:107], v[48:63]
  v_mfma_f32_32x32x16_bf16 v[64:79], a[232:235], a[108:111], v[64:79]
  s_add_u32 s45, s29, 31461376
  buffer_load_dwordx4 a[44:47], v1, s[4:7], s45 offen offset:2048 sc1
  v_mfma_f32_32x32x16_bf16 v[80:95], a[236:239], a[108:111], v[80:95]
  v_mfma_f32_32x32x16_bf16 v[32:47], a[240:243], a[112:115], v[32:47]
  s_add_u32 s44, s28, 31469568
  buffer_load_dwordx4 a[48:51], v1, s[4:7], s44 offen sc1
  v_mfma_f32_32x32x16_bf16 v[48:63], a[244:247], a[112:115], v[48:63]
  v_mfma_f32_32x32x16_bf16 v[64:79], a[240:243], a[116:119], v[64:79]
  s_add_u32 s45, s29, 31469568
  buffer_load_dwordx4 a[52:55], v1, s[4:7], s45 offen sc1
  v_mfma_f32_32x32x16_bf16 v[80:95], a[244:247], a[116:119], v[80:95]
  v_mfma_f32_32x32x16_bf16 v[32:47], a[248:251], a[120:123], v[32:47]
  s_add_u32 s44, s28, 31469568
  buffer_load_dwordx4 a[56:59], v1, s[4:7], s44 offen offset:1024 sc1
  v_mfma_f32_32x32x16_bf16 v[48:63], a[252:255], a[120:123], v[48:63]
  v_mfma_f32_32x32x16_bf16 v[64:79], a[248:251], a[124:127], v[64:79]
  s_add_u32 s45, s29, 31469568
  buffer_load_dwordx4 a[60:63], v1, s[4:7], s45 offen offset:1024 sc1
  v_mfma_f32_32x32x16_bf16 v[80:95], a[252:255], a[124:127], v[80:95]
  v_mfma_f32_32x32x16_bf16 v[32:47], v[160:163], a[0:3], v[32:47]
  s_add_u32 s44, s28, 31473664
  buffer_load_dwordx4 a[64:67], v1, s[4:7], s44 offen offset:3072 sc1
  v_mfma_f32_32x32x16_bf16 v[48:63], v[164:167], a[0:3], v[48:63]
  v_mfma_f32_32x32x16_bf16 v[64:79], v[160:163], a[4:7], v[64:79]
  s_add_u32 s45, s29, 31473664
  buffer_load_dwordx4 a[68:71], v1, s[4:7], s45 offen offset:3072 sc1
  v_mfma_f32_32x32x16_bf16 v[80:95], v[164:167], a[4:7], v[80:95]
  s_waitcnt vmcnt(15)
  v_mfma_f32_32x32x16_bf16 v[32:47], v[168:171], a[8:11], v[32:47]
  s_add_u32 s44, s28, 31477760
  buffer_load_dwordx4 a[72:75], v1, s[4:7], s44 offen sc1
  v_mfma_f32_32x32x16_bf16 v[48:63], v[172:175], a[8:11], v[48:63]
  s_waitcnt vmcnt(15)
  v_mfma_f32_32x32x16_bf16 v[64:79], v[168:171], a[12:15], v[64:79]
  s_add_u32 s45, s29, 31477760
  buffer_load_dwordx4 a[76:79], v1, s[4:7], s45 offen sc1
  v_mfma_f32_32x32x16_bf16 v[80:95], v[172:175], a[12:15], v[80:95]
  s_waitcnt vmcnt(15)
  v_mfma_f32_32x32x16_bf16 v[32:47], v[176:179], a[16:19], v[32:47]
  s_add_u32 s44, s28, 31481856
  buffer_load_dwordx4 a[80:83], v1, s[4:7], s44 offen offset:2048 sc1
  v_mfma_f32_32x32x16_bf16 v[48:63], v[180:183], a[16:19], v[48:63]
  s_waitcnt vmcnt(15)
  v_mfma_f32_32x32x16_bf16 v[64:79], v[176:179], a[20:23], v[64:79]
  s_add_u32 s45, s29, 31481856
  buffer_load_dwordx4 a[84:87], v1, s[4:7], s45 offen offset:2048 sc1
  v_mfma_f32_32x32x16_bf16 v[80:95], v[180:183], a[20:23], v[80:95]
  s_waitcnt vmcnt(15)
  v_mfma_f32_32x32x16_bf16 v[32:47], v[184:187], a[24:27], v[32:47]
  s_add_u32 s44, s28, 31481856
  buffer_load_dwordx4 a[88:91], v1, s[4:7], s44 offen offset:3072 sc1
  v_mfma_f32_32x32x16_bf16 v[48:63], v[188:191], a[24:27], v[48:63]
  s_waitcnt vmcnt(15)
  v_mfma_f32_32x32x16_bf16 v[64:79], v[184:187], a[28:31], v[64:79]
  s_add_u32 s45, s29, 31481856
  buffer_load_dwordx4 a[92:95], v1, s[4:7], s45 offen offset:3072 sc1
  v_mfma_f32_32x32x16_bf16 v[80:95], v[188:191], a[28:31], v[80:95]
  s_waitcnt vmcnt(15)
  v_mfma_f32_32x32x16_bf16 v[32:47], v[192:195], a[32:35], v[32:47]
  s_cbranch_vccnz L_main_skip_76
  s_add_u32 s49, s18, 73728
  s_add_u32 m0, s15, 81920
  s_nop 0
  buffer_load_dwordx4 v1, s[4:7], s49 offen sc1 lds
  buffer_load_dwordx4 v1, s[4:7], s49 offen offset:1024 sc1 lds
L_main_skip_76:
  v_mfma_f32_32x32x16_bf16 v[48:63], v[196:199], a[32:35], v[48:63]
  s_waitcnt vmcnt(16)
  s_cbranch_vccz L_main_w_120
  s_waitcnt vmcnt(14)
L_main_w_120:
  v_mfma_f32_32x32x16_bf16 v[64:79], v[192:195], a[36:39], v[64:79]
  v_mfma_f32_32x32x16_bf16 v[80:95], v[196:199], a[36:39], v[80:95]
  s_waitcnt vmcnt(15)
  s_cbranch_vccz L_main_w_121
  s_waitcnt vmcnt(13)
L_main_w_121:
  v_mfma_f32_32x32x16_bf16 v[32:47], v[200:203], a[40:43], v[32:47]
  v_mfma_f32_32x32x16_bf16 v[48:63], v[204:207], a[40:43], v[48:63]
  s_waitcnt vmcnt(14)
  s_cbranch_vccz L_main_w_122
  s_waitcnt vmcnt(12)
L_main_w_122:
  v_mfma_f32_32x32x16_bf16 v[64:79], v[200:203], a[44:47], v[64:79]
  v_mfma_f32_32x32x16_bf16 v[80:95], v[204:207], a[44:47], v[80:95]
  s_cbranch_vccnz L_main_skip_77
  buffer_load_dwordx4 v1, s[4:7], s49 offen offset:2048 sc1 lds
  buffer_load_dwordx4 v1, s[4:7], s49 offen offset:3072 sc1 lds
L_main_skip_77:
  s_waitcnt vmcnt(15)
  s_cbranch_vccz L_main_w_123
  s_waitcnt vmcnt(11)
L_main_w_123:
  v_mfma_f32_32x32x16_bf16 v[32:47], v[208:211], a[48:51], v[32:47]
  v_mfma_f32_32x32x16_bf16 v[48:63], v[212:215], a[48:51], v[48:63]
  s_waitcnt vmcnt(14)
  s_cbranch_vccz L_main_w_124
  s_waitcnt vmcnt(10)
L_main_w_124:
  v_mfma_f32_32x32x16_bf16 v[64:79], v[208:211], a[52:55], v[64:79]
  v_mfma_f32_32x32x16_bf16 v[80:95], v[212:215], a[52:55], v[80:95]
  s_waitcnt vmcnt(13)
  s_cbranch_vccz L_main_w_125
  s_waitcnt vmcnt(9)
L_main_w_125:
  v_mfma_f32_32x32x16_bf16 v[32:47], v[216:219], a[56:59], v[32:47]
  v_mfma_f32_32x32x16_bf16 v[48:63], v[220:223], a[56:59], v[48:63]
  s_waitcnt vmcnt(12)
  s_cbranch_vccz L_main_w_126
  s_waitcnt vmcnt(8)
L_main_w_126:
  v_mfma_f32_32x32x16_bf16 v[64:79], v[216:219], a[60:63], v[64:79]
  v_mfma_f32_32x32x16_bf16 v[80:95], v[220:223], a[60:63], v[80:95]
  s_cbranch_vccnz L_main_skip_78
  s_add_u32 s49, s18, 106496
  s_add_u32 m0, s15, 98304
  s_nop 0
  buffer_load_dwordx4 v1, s[4:7], s49 offen sc1 lds
  buffer_load_dwordx4 v1, s[4:7], s49 offen offset:1024 sc1 lds
L_main_skip_78:
  s_waitcnt vmcnt(13)
  s_cbranch_vccz L_main_w_127
  s_waitcnt vmcnt(7)
L_main_w_127:
  v_mfma_f32_32x32x16_bf16 v[32:47], v[224:227], a[64:67], v[32:47]
  v_mfma_f32_32x32x16_bf16 v[48:63], v[228:231], a[64:67], v[48:63]
  s_waitcnt vmcnt(12)
  s_cbranch_vccz L_main_w_128
  s_waitcnt vmcnt(6)
L_main_w_128:
  v_mfma_f32_32x32x16_bf16 v[64:79], v[224:227], a[68:71], v[64:79]
  v_mfma_f32_32x32x16_bf16 v[80:95], v[228:231], a[68:71], v[80:95]
  s_waitcnt vmcnt(10)
  s_cbranch_vccz L_main_w_129
  s_waitcnt vmcnt(4)
L_main_w_129:
  v_mfma_f32_32x32x16_bf16 v[80:95], v[236:239], a[76:79], v[80:95]
  s_waitcnt vmcnt(8)
  s_cbranch_vccz L_main_w_130
  s_waitcnt vmcnt(2)
L_main_w_130:
  v_mfma_f32_32x32x16_bf16 v[80:95], v[244:247], a[84:87], v[80:95]
  s_waitcnt vmcnt(6)
  s_cbranch_vccz L_main_w_131
  s_waitcnt vmcnt(0)
L_main_w_131:
  v_mfma_f32_32x32x16_bf16 v[80:95], v[252:255], a[92:95], v[80:95]
  s_cbranch_vccnz L_main_skip_79
  buffer_load_dwordx4 v1, s[4:7], s49 offen offset:2048 sc1 lds
  buffer_load_dwordx4 v1, s[4:7], s49 offen offset:3072 sc1 lds
L_main_skip_79:
  v_mfma_f32_32x32x16_bf16 v[64:79], v[232:235], a[76:79], v[64:79]
  v_mfma_f32_32x32x16_bf16 v[64:79], v[240:243], a[84:87], v[64:79]
  v_mfma_f32_32x32x16_bf16 v[64:79], v[248:251], a[92:95], v[64:79]
  v_mfma_f32_32x32x16_bf16 v[48:63], v[236:239], a[72:75], v[48:63]
  s_nop 6
  ds_write_b128 v14, v[80:83] offset:16384
  ds_write_b128 v14, v[84:87] offset:17408
  v_mfma_f32_32x32x16_bf16 v[48:63], v[244:247], a[80:83], v[48:63]
  ds_write_b128 v14, v[88:91] offset:18432
  v_mfma_f32_32x32x16_bf16 v[48:63], v[252:255], a[88:91], v[48:63]
  ds_write_b128 v14, v[92:95] offset:19456
  v_mfma_f32_32x32x16_bf16 v[32:47], v[232:235], a[72:75], v[32:47]
  ds_write_b128 v13, v[64:67] offset:16384
  ds_write_b128 v13, v[68:71] offset:17408
  v_mfma_f32_32x32x16_bf16 v[32:47], v[240:243], a[80:83], v[32:47]
  ds_write_b128 v13, v[72:75] offset:18432
  v_mfma_f32_32x32x16_bf16 v[32:47], v[248:251], a[88:91], v[32:47]
  ds_write_b128 v13, v[76:79] offset:19456
  s_nop 3
  ds_write_b128 v12, v[48:51] offset:16384
  ds_write_b128 v12, v[52:55] offset:17408
  ds_write_b128 v12, v[56:59] offset:18432
  ds_write_b128 v12, v[60:63] offset:19456
  s_waitcnt lgkmcnt(0)
  s_barrier
  ds_read_b128 v[48:51], v15 offset:16384
  ds_read_b128 v[52:55], v15 offset:17408
  ds_read_b128 v[56:59], v15 offset:18432
  ds_read_b128 v[60:63], v15 offset:19456
  ds_read_b128 v[64:67], v15 offset:20480
  ds_read_b128 v[68:71], v15 offset:21504
  ds_read_b128 v[72:75], v15 offset:22528
  ds_read_b128 v[76:79], v15 offset:23552
  ds_read_b128 v[80:83], v15 offset:24576
  ds_read_b128 v[84:87], v15 offset:25600
  ds_read_b128 v[88:91], v15 offset:26624
  ds_read_b128 v[92:95], v15 offset:27648
  s_waitcnt lgkmcnt(11)
  v_pk_add_f32 v[32:33], v[32:33], v[48:49]
  v_pk_add_f32 v[34:35], v[34:35], v[50:51]
  s_waitcnt lgkmcnt(10)
  v_pk_add_f32 v[36:37], v[36:37], v[52:53]
  v_pk_add_f32 v[38:39], v[38:39], v[54:55]
  s_waitcnt lgkmcnt(9)
  v_pk_add_f32 v[40:41], v[40:41], v[56:57]
  v_pk_add_f32 v[42:43], v[42:43], v[58:59]
  s_waitcnt lgkmcnt(8)
  v_pk_add_f32 v[44:45], v[44:45], v[60:61]
  v_pk_add_f32 v[46:47], v[46:47], v[62:63]
  s_waitcnt lgkmcnt(7)
  v_pk_add_f32 v[32:33], v[32:33], v[64:65]
  v_pk_add_f32 v[34:35], v[34:35], v[66:67]
  s_waitcnt lgkmcnt(6)
  v_pk_add_f32 v[36:37], v[36:37], v[68:69]
  v_pk_add_f32 v[38:39], v[38:39], v[70:71]
  s_waitcnt lgkmcnt(5)
  v_pk_add_f32 v[40:41], v[40:41], v[72:73]
  v_pk_add_f32 v[42:43], v[42:43], v[74:75]
  s_waitcnt lgkmcnt(4)
  v_pk_add_f32 v[44:45], v[44:45], v[76:77]
  v_pk_add_f32 v[46:47], v[46:47], v[78:79]
  s_waitcnt lgkmcnt(3)
  v_pk_add_f32 v[32:33], v[32:33], v[80:81]
  v_pk_add_f32 v[34:35], v[34:35], v[82:83]
  s_waitcnt lgkmcnt(2)
  v_pk_add_f32 v[36:37], v[36:37], v[84:85]
  v_pk_add_f32 v[38:39], v[38:39], v[86:87]
  s_waitcnt lgkmcnt(1)
  v_pk_add_f32 v[40:41], v[40:41], v[88:89]
  v_pk_add_f32 v[42:43], v[42:43], v[90:91]
  s_waitcnt lgkmcnt(0)
  v_pk_add_f32 v[44:45], v[44:45], v[92:93]
  v_pk_add_f32 v[46:47], v[46:47], v[94:95]
  v_cvt_pk_bf16_f32 v48, v32, v33
  v_cvt_pk_bf16_f32 v49, v34, v35
  v_cvt_pk_bf16_f32 v50, v36, v37
  v_cvt_pk_bf16_f32 v51, v38, v39
  v_cvt_pk_bf16_f32 v52, v40, v41
  v_cvt_pk_bf16_f32 v53, v42, v43
  v_cvt_pk_bf16_f32 v54, v44, v45
  v_cvt_pk_bf16_f32 v55, v46, v47
  s_cbranch_vccnz L_main_final_80
  s_add_u32 s44, s32, 26738688
  buffer_store_dwordx4 v[48:51], v1, s[4:7], s44 offen sc1
  buffer_store_dwordx4 v[52:55], v1, s[4:7], s44 offen offset:1024 sc1
  v_dot2_f32_bf16 v27, v48, v8, 0
  v_dot2_f32_bf16 v28, v48, v48, 0
  v_dot2_f32_bf16 v27, v49, v8, v27
  v_dot2_f32_bf16 v28, v49, v49, v28
  v_dot2_f32_bf16 v27, v50, v8, v27
  v_dot2_f32_bf16 v28, v50, v50, v28
  v_dot2_f32_bf16 v27, v51, v8, v27
  v_dot2_f32_bf16 v28, v51, v51, v28
  v_dot2_f32_bf16 v27, v52, v8, v27
  v_dot2_f32_bf16 v28, v52, v52, v28
  v_dot2_f32_bf16 v27, v53, v8, v27
  v_dot2_f32_bf16 v28, v53, v53, v28
  v_dot2_f32_bf16 v27, v54, v8, v27
  v_dot2_f32_bf16 v28, v54, v54, v28
  v_dot2_f32_bf16 v27, v55, v8, v27
  v_dot2_f32_bf16 v28, v55, v55, v28
  s_nop 2
  v_permlane32_swap_b32 v27, v28
  v_add_f32 v27, v27, v28
  s_add_u32 s45, s33, 29097984
  buffer_store_dword v27, v4, s[4:7], s45 offen sc1
  s_add_u32 s64, s77, 2
  v_mov_b32 v29, s64
  s_waitcnt vmcnt(0)
  s_mov_b64 exec, 1
  s_cmp_eq_u32 s76, 0
  s_cbranch_scc1 L_main_pslow_81
  buffer_store_dword v29, off, s[4:7], s101
L_main_pdone_82:
  s_mov_b64 exec, -1
  s_barrier
  s_add_u32 s34, s34, 14745600
  s_add_u32 s35, s35, 14745600
  s_add_u32 s41, s41, 14745600
  s_add_u32 s36, s36, 32768
  s_add_u32 s37, s37, 32768
  s_mov_b64 vcc, -1
  buffer_load_dword v30, v10, s[4:7], 0 offen sc1
  s_add_u32 s62, s77, 2
  s_mov_b32 s63, 0
  s_waitcnt vmcnt(0)
  v_cmp_gt_u32 s[64:65], s62, v30
  s_nop 3
  s_cmp_lg_u64 s[64:65], 0
  s_cbranch_scc1 L_main_floop_83
L_main_finv_85:
L_main_fdone_84:
  s_mov_b32 s77, 3
  s_add_u32 s44, s16, 26738688
  buffer_load_dwordx4 a[0:3], v1, s[4:7], s44 offen sc1
  buffer_load_dwordx4 a[4:7], v1, s[4:7], s44 offen offset:1024 sc1
  buffer_load_dwordx4 a[8:11], v1, s[4:7], s44 offen offset:2048 sc1
  buffer_load_dwordx4 a[12:15], v1, s[4:7], s44 offen offset:3072 sc1
  s_add_u32 s49, s18, 90112
  s_add_u32 m0, s15, 114688
  s_nop 0
  buffer_load_dwordx4 v1, s[4:7], s49 offen sc1 lds
  s_add_u32 s44, s16, 26742784
  buffer_load_dwordx4 a[16:19], v1, s[4:7], s44 offen sc1
  buffer_load_dwordx4 v1, s[4:7], s49 offen offset:1024 sc1 lds
  buffer_load_dwordx4 a[20:23], v1, s[4:7], s44 offen offset:1024 sc1
  ds_read_b128 v[96:99], v2 offset:16384
  ds_read_b128 v[100:103], v2 offset:32768
  ds_read_b128 v[104:107], v2 offset:17408
  ds_read_b128 v[108:111], v2 offset:33792
  ds_read_b128 v[112:115], v2 offset:18432
  ds_read_b128 v[116:119], v2 offset:34816
  ds_read_b128 v[120:123], v2 offset:19456
  ds_read_b128 v[124:127], v2 offset:35840
  s_waitcnt vmcnt(7) lgkmcnt(7)
  v_mfma_f32_32x32x16_bf16 v[32:47], a[0:3], v[96:99], 0
  buffer_load_dwordx4 v1, s[4:7], s49 offen offset:2048 sc1 lds
  s_add_u32 s45, s17, 29097984
  buffer_load_dword v80, v4, s[4:7], s45 offen sc1
  s_waitcnt lgkmcnt(6)
  v_mfma_f32_32x32x16_bf16 v[48:63], a[0:3], v[100:103], 0
  buffer_load_dwordx4 a[24:27], v1, s[4:7], s44 offen offset:2048 sc1
  buffer_load_dword v81, v4, s[4:7], s45 offen offset:256 sc1
  ds_read_b128 v[96:99], v2 offset:20480
  ds_read_b128 v[100:103], v2 offset:36864
  s_waitcnt vmcnt(10) lgkmcnt(7)
  v_mfma_f32_32x32x16_bf16 v[32:47], a[4:7], v[104:107], v[32:47]
  buffer_load_dwordx4 v1, s[4:7], s49 offen offset:3072 sc1 lds
  buffer_load_dword v82, v4, s[4:7], s45 offen offset:512 sc1
  s_waitcnt lgkmcnt(6)
  v_mfma_f32_32x32x16_bf16 v[48:63], a[4:7], v[108:111], v[48:63]
  buffer_load_dword v83, v4, s[4:7], s45 offen offset:768 sc1
  ds_read_b128 v[104:107], v2 offset:21504
  ds_read_b128 v[108:111], v2 offset:37888
  s_waitcnt vmcnt(12) lgkmcnt(7)
  v_mfma_f32_32x32x16_bf16 v[32:47], a[8:11], v[112:115], v[32:47]
  buffer_load_dwordx4 a[28:31], v1, s[4:7], s44 offen offset:3072 sc1
  buffer_load_dword v84, v4, s[4:7], s45 offen offset:1024 sc1
  s_waitcnt lgkmcnt(6)
  v_mfma_f32_32x32x16_bf16 v[48:63], a[8:11], v[116:119], v[48:63]
  s_add_u32 s49, s18, 122880
  s_add_u32 m0, s15, 131072
  s_nop 0
  buffer_load_dwordx4 v1, s[4:7], s49 offen sc1 lds
  buffer_load_dword v85, v4, s[4:7], s45 offen offset:1280 sc1
  ds_read_b128 v[112:115], v2 offset:22528
  ds_read_b128 v[116:119], v2 offset:38912
  s_waitcnt vmcnt(15) lgkmcnt(7)
  v_mfma_f32_32x32x16_bf16 v[32:47], a[12:15], v[120:123], v[32:47]
  buffer_load_dword v86, v4, s[4:7], s45 offen offset:1536 sc1
  s_waitcnt lgkmcnt(6)
  v_mfma_f32_32x32x16_bf16 v[48:63], a[12:15], v[124:127], v[48:63]
  s_add_u32 s44, s16, 26746880
  buffer_load_dwordx4 a[32:35], v1, s[4:7], s44 offen sc1
  buffer_load_dword v87, v4, s[4:7], s45 offen offset:1792 sc1
  ds_read_b128 v[120:123], v2 offset:23552
  ds_read_b128 v[124:127], v2 offset:39936
  s_waitcnt vmcnt(16) lgkmcnt(7)
  v_mfma_f32_32x32x16_bf16 v[32:47], a[16:19], v[96:99], v[32:47]
  buffer_load_dwordx4 v1, s[4:7], s49 offen offset:1024 sc1 lds
  buffer_load_dword v88, v4, s[4:7], s45 offen offset:2048 sc1
  s_waitcnt lgkmcnt(6)
  v_mfma_f32_32x32x16_bf16 v[48:63], a[16:19], v[100:103], v[48:63]
  buffer_load_dword v89, v4, s[4:7], s45 offen offset:2304 sc1
  ds_read_b128 v[96:99], v2 offset:24576
  ds_read_b128 v[100:103], v2 offset:40960
  s_waitcnt vmcnt(17) lgkmcnt(7)
  v_mfma_f32_32x32x16_bf16 v[32:47], a[20:23], v[104:107], v[32:47]
  buffer_load_dwordx4 a[36:39], v1, s[4:7], s44 offen offset:1024 sc1
  buffer_load_dword v90, v4, s[4:7], s45 offen offset:2560 sc1
  s_waitcnt lgkmcnt(6)
  v_mfma_f32_32x32x16_bf16 v[48:63], a[20:23], v[108:111], v[48:63]
  buffer_load_dwordx4 v1, s[4:7], s49 offen offset:2048 sc1 lds
  buffer_load_dword v91, v4, s[4:7], s45 offen offset:2816 sc1
  ds_read_b128 v[104:107], v2 offset:25600
  ds_read_b128 v[108:111], v2 offset:41984
  s_waitcnt vmcnt(18) lgkmcnt(7)
  v_mfma_f32_32x32x16_bf16 v[32:47], a[24:27], v[112:115], v[32:47]
  buffer_load_dword v92, v4, s[4:7], s45 offen offset:3072 sc1
  s_waitcnt lgkmcnt(6)
  v_mfma_f32_32x32x16_bf16 v[48:63], a[24:27], v[116:119], v[48:63]
  buffer_load_dwordx4 a[40:43], v1, s[4:7], s44 offen offset:2048 sc1
  buffer_load_dword v93, v4, s[4:7], s45 offen offset:3328 sc1
  ds_read_b128 v[112:115], v2 offset:26624
  ds_read_b128 v[116:119], v2 offset:43008
  s_waitcnt vmcnt(16) lgkmcnt(7)
  v_mfma_f32_32x32x16_bf16 v[32:47], a[28:31], v[120:123], v[32:47]
  buffer_load_dwordx4 v1, s[4:7], s49 offen offset:3072 sc1 lds
  buffer_load_dword v94, v4, s[4:7], s45 offen offset:3584 sc1
  s_waitcnt lgkmcnt(6)
  v_mfma_f32_32x32x16_bf16 v[48:63], a[28:31], v[124:127], v[48:63]
  buffer_load_dword v95, v4, s[4:7], s45 offen offset:3840 sc1
  ds_read_b128 v[120:123], v2 offset:27648
  ds_read_b128 v[124:127], v2 offset:44032
  s_waitcnt vmcnt(14) lgkmcnt(7)
  v_mfma_f32_32x32x16_bf16 v[32:47], a[32:35], v[96:99], v[32:47]
  buffer_load_dwordx4 a[44:47], v1, s[4:7], s44 offen offset:3072 sc1
  s_waitcnt lgkmcnt(6)
  v_mfma_f32_32x32x16_bf16 v[48:63], a[32:35], v[100:103], v[48:63]
  s_add_u32 s44, s16, 26750976
  buffer_load_dwordx4 a[48:51], v1, s[4:7], s44 offen sc1
  ds_read_b128 v[96:99], v2 offset:28672
  ds_read_b128 v[100:103], v2 offset:45056
  s_waitcnt vmcnt(11) lgkmcnt(7)
  v_mfma_f32_32x32x16_bf16 v[32:47], a[36:39], v[104:107], v[32:47]
  s_waitcnt lgkmcnt(6)
  v_mfma_f32_32x32x16_bf16 v[48:63], a[36:39], v[108:111], v[48:63]
  buffer_load_dwordx4 a[52:55], v1, s[4:7], s44 offen offset:1024 sc1
  ds_read_b128 v[104:107], v2 offset:29696
  ds_read_b128 v[108:111], v2 offset:46080
  s_waitcnt vmcnt(7) lgkmcnt(7)
  v_mfma_f32_32x32x16_bf16 v[32:47], a[40:43], v[112:115], v[32:47]
  buffer_load_dwordx4 a[56:59], v1, s[4:7], s44 offen offset:2048 sc1
  s_waitcnt lgkmcnt(6)
  v_mfma_f32_32x32x16_bf16 v[48:63], a[40:43], v[116:119], v[48:63]
  ds_read_b128 v[112:115], v2 offset:30720
  ds_read_b128 v[116:119], v2 offset:47104
  s_waitcnt vmcnt(3) lgkmcnt(7)
  v_mfma_f32_32x32x16_bf16 v[32:47], a[44:47], v[120:123], v[32:47]
  buffer_load_dwordx4 a[60:63], v1, s[4:7], s44 offen offset:3072 sc1
  s_waitcnt lgkmcnt(6)
  v_mfma_f32_32x32x16_bf16 v[48:63], a[44:47], v[124:127], v[48:63]
  s_add_u32 s44, s16, 26755072
  buffer_load_dwordx4 a[64:67], v1, s[4:7], s44 offen sc1
  ds_read_b128 v[120:123], v2 offset:31744
  ds_read_b128 v[124:127], v2 offset:48128
  s_waitcnt vmcnt(4) lgkmcnt(7)
  v_mfma_f32_32x32x16_bf16 v[32:47], a[48:51], v[96:99], v[32:47]
  s_waitcnt lgkmcnt(6)
  v_mfma_f32_32x32x16_bf16 v[48:63], a[48:51], v[100:103], v[48:63]
  buffer_load_dwordx4 a[68:71], v1, s[4:7], s44 offen offset:1024 sc1
  s_barrier
  ds_read_b128 v[96:99], v2 offset:49152
  ds_read_b128 v[100:103], v3
  s_waitcnt vmcnt(4) lgkmcnt(7)
  v_mfma_f32_32x32x16_bf16 v[32:47], a[52:55], v[104:107], v[32:47]
  buffer_load_dwordx4 a[72:75], v1, s[4:7], s44 offen offset:2048 sc1
  s_waitcnt lgkmcnt(6)
  v_mfma_f32_32x32x16_bf16 v[48:63], a[52:55], v[108:111], v[48:63]
  buffer_load_dwordx4 a[76:79], v1, s[4:7], s44 offen offset:3072 sc1
  ds_read_b128 v[104:107], v2 offset:50176
  ds_read_b128 v[108:111], v3 offset:1024
  s_waitcnt vmcnt(5) lgkmcnt(7)
  v_mfma_f32_32x32x16_bf16 v[32:47], a[56:59], v[112:115], v[32:47]
  s_waitcnt lgkmcnt(6)
  v_mfma_f32_32x32x16_bf16 v[48:63], a[56:59], v[116:119], v[48:63]
  s_add_u32 s44, s16, 26759168
  buffer_load_dwordx4 a[80:83], v1, s[4:7], s44 offen sc1
  ds_read_b128 v[112:115], v2 offset:51200
  ds_read_b128 v[116:119], v3 offset:2048
  s_waitcnt vmcnt(5) lgkmcnt(7)
  v_mfma_f32_32x32x16_bf16 v[32:47], a[60:63], v[120:123], v[32:47]
  buffer_load_dwordx4 a[84:87], v1, s[4:7], s44 offen offset:1024 sc1
  s_waitcnt lgkmcnt(6)
  v_mfma_f32_32x32x16_bf16 v[48:63], a[60:63], v[124:127], v[48:63]
  ds_read_b128 v[120:123], v2 offset:52224
  ds_read_b128 v[124:127], v3 offset:3072
  s_waitcnt vmcnt(5) lgkmcnt(7)
  v_mfma_f32_32x32x16_bf16 v[32:47], a[64:67], v[96:99], v[32:47]
  buffer_load_dwordx4 a[88:91], v1, s[4:7], s44 offen offset:2048 sc1
  s_waitcnt lgkmcnt(6)
  v_mfma_f32_32x32x16_bf16 v[48:63], a[64:67], v[100:103], v[48:63]
  buffer_load_dwordx4 a[92:95], v1, s[4:7], s44 offen offset:3072 sc1
  ds_read_b128 v[96:99], v2 offset:53248
  ds_read_b128 v[100:103], v3 offset:4096
  s_waitcnt vmcnt(6) lgkmcnt(7)
  v_mfma_f32_32x32x16_bf16 v[32:47], a[68:71], v[104:107], v[32:47]
  s_waitcnt lgkmcnt(6)
  v_mfma_f32_32x32x16_bf16 v[48:63], a[68:71], v[108:111], v[48:63]
  s_add_u32 s44, s16, 26763264
  buffer_load_dwordx4 a[96:99], v1, s[4:7], s44 offen sc1
  ds_read_b128 v[104:107], v2 offset:54272
  ds_read_b128 v[108:111], v3 offset:5120
  s_waitcnt vmcnt(6) lgkmcnt(7)
  v_mfma_f32_32x32x16_bf16 v[32:47], a[72:75], v[112:115], v[32:47]
  buffer_load_dwordx4 a[100:103], v1, s[4:7], s44 offen offset:1024 sc1
  v_add_f32 v80, v80, v88
  v_add_f32 v81, v81, v89
  s_waitcnt lgkmcnt(6)
  v_mfma_f32_32x32x16_bf16 v[48:63], a[72:75], v[116:119], v[48:63]
  v_add_f32 v82, v82, v90
  v_add_f32 v83, v83, v91
  ds_read_b128 v[112:115], v2 offset:55296
  ds_read_b128 v[116:119], v3 offset:6144
  s_waitcnt vmcnt(6) lgkmcnt(7)
  v_mfma_f32_32x32x16_bf16 v[32:47], a[76:79], v[120:123], v[32:47]
  buffer_load_dwordx4 a[104:107], v1, s[4:7], s44 offen offset:2048 sc1
  v_add_f32 v84, v84, v92
  s_waitcnt lgkmcnt(6)
  v_mfma_f32_32x32x16_bf16 v[48:63], a[76:79], v[124:127], v[48:63]
  buffer_load_dwordx4 a[108:111], v1, s[4:7], s44 offen offset:3072 sc1
  v_add_f32 v85, v85, v93
  v_add_f32 v86, v86, v94
  s_barrier
  ds_read_b128 v[120:123], v2 offset:56320
  ds_read_b128 v[124:127], v3 offset:7168
  s_waitcnt vmcnt(7) lgkmcnt(7)
  v_mfma_f32_32x32x16_bf16 v[32:47], a[80:83], v[96:99], v[32:47]
  v_add_f32 v87, v87, v95
  s_waitcnt lgkmcnt(6)
  v_mfma_f32_32x32x16_bf16 v[48:63], a[80:83], v[100:103], v[48:63]
  s_add_u32 s44, s16, 26767360
  buffer_load_dwordx4 a[112:115], v1, s[4:7], s44 offen sc1
  v_add_f32 v80, v80, v84
  v_add_f32 v81, v81, v85
  ds_read_b128 v[96:99], v2 offset:57344
  ds_read_b128 v[100:103], v3 offset:8192
  s_waitcnt vmcnt(7) lgkmcnt(7)
  v_mfma_f32_32x32x16_bf16 v[32:47], a[84:87], v[104:107], v[32:47]
  buffer_load_dwordx4 a[116:119], v1, s[4:7], s44 offen offset:1024 sc1
  v_add_f32 v82, v82, v86
  v_add_f32 v83, v83, v87
  s_waitcnt lgkmcnt(6)
  v_mfma_f32_32x32x16_bf16 v[48:63], a[84:87], v[108:111], v[48:63]
  v_add_f32 v80, v80, v82
  ds_read_b128 v[104:107], v2 offset:58368
  ds_read_b128 v[108:111], v3 offset:9216
  s_waitcnt vmcnt(7) lgkmcnt(7)
  v_mfma_f32_32x32x16_bf16 v[32:47], a[88:91], v[112:115], v[32:47]
  buffer_load_dwordx4 a[120:123], v1, s[4:7], s44 offen offset:2048 sc1
  v_add_f32 v81, v81, v83
  v_add_f32 v80, v80, v81
  s_waitcnt lgkmcnt(6)
  v_mfma_f32_32x32x16_bf16 v[48:63], a[88:91], v[116:119], v[48:63]
  buffer_load_dwordx4 a[124:127], v1, s[4:7], s44 offen offset:3072 sc1
  v_mov_b32 v81, v80
  ds_read_b128 v[112:115], v2 offset:59392
  ds_read_b128 v[116:119], v3 offset:10240
  s_waitcnt vmcnt(8) lgkmcnt(7)
  v_mfma_f32_32x32x16_bf16 v[32:47], a[92:95], v[120:123], v[32:47]
  v_permlane32_swap_b32 v80, v81
  v_mul_f32 v80, 0xbb000000, v80
  s_waitcnt lgkmcnt(6)
  v_mfma_f32_32x32x16_bf16 v[48:63], a[92:95], v[124:127], v[48:63]
  s_add_u32 s46, s20, 1646592
  buffer_load_dwordx2 v[132:133], v11, s[4:7], s46 offen sc1
  buffer_load_dwordx2 v[134:135], v11, s[4:7], s46 offen offset:256 sc1
  v_mul_f32 v81, 0x3b000000, v81
  ds_read_b128 v[120:123], v2 offset:60416
  ds_read_b128 v[124:127], v3 offset:11264
  s_waitcnt vmcnt(9) lgkmcnt(7)
  v_mfma_f32_32x32x16_bf16 v[32:47], a[96:99], v[96:99], v[32:47]
  buffer_load_dwordx2 v[136:137], v11, s[4:7], s46 offen offset:1024 sc1
  buffer_load_dwordx2 v[138:139], v11, s[4:7], s46 offen offset:1280 sc1
  v_fma_f32 v81, -v80, v80, v81
  v_max_f32 v81, 0, v81
  s_waitcnt lgkmcnt(6)
  v_mfma_f32_32x32x16_bf16 v[48:63], a[96:99], v[100:103], v[48:63]
  v_add_f32 v81, 0x3727c5ac, v81
  v_rsq_f32 v18, v81
  ds_read_b128 v[96:99], v2 offset:61440
  ds_read_b128 v[100:103], v3 offset:12288
  s_waitcnt vmcnt(10) lgkmcnt(7)
  v_mfma_f32_32x32x16_bf16 v[32:47], a[100:103], v[104:107], v[32:47]
  v_cvt_pk_bf16_f32 v82, v80, v80
  s_add_u32 s49, s18, 139264
  s_add_u32 m0, s15, 81920
  s_nop 0
  buffer_load_dwordx4 v1, s[4:7], s49 offen sc1 lds
  s_waitcnt lgkmcnt(6)
  v_mfma_f32_32x32x16_bf16 v[48:63], a[100:103], v[108:111], v[48:63]
  v_and_b32 v82, 0xffff0000, v82
  v_sub_f32 v82, v80, v82
  ds_read_b128 v[104:107], v2 offset:62464
  ds_read_b128 v[108:111], v3 offset:13312
  s_waitcnt vmcnt(10) lgkmcnt(7)
  v_mfma_f32_32x32x16_bf16 v[32:47], a[104:107], v[112:115], v[32:47]
  v_cvt_pk_bf16_f32 v20, v80, v82
  buffer_load_dwordx4 v1, s[4:7], s49 offen offset:1024 sc1 lds
  s_waitcnt lgkmcnt(6)
  v_mfma_f32_32x32x16_bf16 v[48:63], a[104:107], v[116:119], v[48:63]
  v_mul_f32 v19, 0x3fb8aa3b, v18
  v_mov_b32 v21, v20
  ds_read_b128 v[112:115], v2 offset:63488
  ds_read_b128 v[116:119], v3 offset:14336
  s_waitcnt vmcnt(10) lgkmcnt(7)
  v_mfma_f32_32x32x16_bf16 v[32:47], a[108:111], v[120:123], v[32:47]
  v_mov_b32 v22, v20
  s_waitcnt lgkmcnt(6)
  v_mfma_f32_32x32x16_bf16 v[48:63], a[108:111], v[124:127], v[48:63]
  v_mov_b32 v23, v20
  v_cndmask_b32 v27, v18, v19, s[60:61]
  buffer_load_dwordx4 v1, s[4:7], s49 offen offset:2048 sc1 lds
  ds_read_b128 v[120:123], v2 offset:64512
  ds_read_b128 v[124:127], v3 offset:15360
  s_waitcnt vmcnt(10) lgkmcnt(7)
  v_mfma_f32_32x32x16_bf16 v[32:47], a[112:115], v[96:99], v[32:47]
  ds_write_b32 v24, v27
  ds_read_b128 v[144:147], v25 offset:0
  s_waitcnt lgkmcnt(8)
  v_mfma_f32_32x32x16_bf16 v[48:63], a[112:115], v[100:103], v[48:63]
  ds_read_b128 v[148:151], v25 offset:32
  s_waitcnt vmcnt(9) lgkmcnt(8)
  v_mfma_f32_32x32x16_bf16 v[32:47], a[116:119], v[104:107], v[32:47]
  ds_read_b128 v[152:155], v25 offset:64
  ds_read_b128 v[156:159], v25 offset:96
  buffer_load_dwordx4 v1, s[4:7], s49 offen offset:3072 sc1 lds
  s_waitcnt lgkmcnt(9)
  v_mfma_f32_32x32x16_bf16 v[48:63], a[116:119], v[108:111], v[48:63]
  ds_read_b128 v[80:83], v25 offset:128
  s_waitcnt vmcnt(9) lgkmcnt(9)
  v_mfma_f32_32x32x16_bf16 v[32:47], a[120:123], v[112:115], v[32:47]
  ds_read_b128 v[84:87], v25 offset:160
  ds_read_b128 v[88:91], v25 offset:192
  s_waitcnt lgkmcnt(10)
  v_mfma_f32_32x32x16_bf16 v[48:63], a[120:123], v[116:119], v[48:63]
  ds_read_b128 v[92:95], v25 offset:224
  s_add_u32 s49, s18, 155648
  s_add_u32 m0, s15, 98304
  s_nop 0
  buffer_load_dwordx4 v1, s[4:7], s49 offen sc1 lds
  s_waitcnt vmcnt(9) lgkmcnt(10)
  v_mfma_f32_32x32x16_bf16 v[32:47], a[124:127], v[120:123], v[32:47]
  s_waitcnt lgkmcnt(9)
  v_mfma_f32_32x32x16_bf16 v[48:63], a[124:127], v[124:127], v[48:63]
  s_waitcnt vmcnt(5)
  v_mfma_f32_32x32x16_bf16 v[48:63], v[20:23], v[136:139], v[48:63]
  v_mfma_f32_32x32x16_bf16 v[32:47], v[20:23], v[132:135], v[32:47]
  buffer_load_dwordx4 v1, s[4:7], s49 offen offset:1024 sc1 lds
  s_waitcnt lgkmcnt(3)
  s_nop 8
  v_mul_f32 v48, v48, v80
  v_mul_f32 v49, v49, v81
  v_cvt_pk_bf16_f32 v132, v48, v49
  v_mul_f32 v50, v50, v82
  v_mul_f32 v51, v51, v83
  v_cvt_pk_bf16_f32 v133, v50, v51
  s_waitcnt lgkmcnt(2)
  v_mul_f32 v52, v52, v84
  v_mul_f32 v53, v53, v85
  v_cvt_pk_bf16_f32 v134, v52, v53
  v_mul_f32 v54, v54, v86
  v_mul_f32 v55, v55, v87
  v_cvt_pk_bf16_f32 v135, v54, v55
  s_waitcnt lgkmcnt(1)
  v_mul_f32 v56, v56, v88
  v_mul_f32 v57, v57, v89
  v_cvt_pk_bf16_f32 v136, v56, v57
  v_mul_f32 v58, v58, v90
  buffer_load_dwordx4 v1, s[4:7], s49 offen offset:2048 sc1 lds
  v_mul_f32 v59, v59, v91
  v_cvt_pk_bf16_f32 v137, v58, v59
  s_waitcnt lgkmcnt(0)
  v_mul_f32 v60, v60, v92
  v_mul_f32 v61, v61, v93
  v_cvt_pk_bf16_f32 v138, v60, v61
  v_mul_f32 v62, v62, v94
  v_mul_f32 v63, v63, v95
  v_cvt_pk_bf16_f32 v139, v62, v63
  v_mov_b32 v80, v8
  v_mov_b32 v81, v8
  v_mov_b32 v82, v8
  v_mov_b32 v83, v8
  v_fma_f32 v32, v32, v144, s39
  v_exp_f32 v27, v32 clamp
  v_max_f32 v32, s39, v32
  v_fma_f32 v33, v33, v145, s39
  buffer_load_dwordx4 v1, s[4:7], s49 offen offset:3072 sc1 lds
  v_fma_f32 v32, v32, s40, v27
  v_exp_f32 v28, v33 clamp
  v_max_f32 v33, s39, v33
  v_fma_f32 v34, v34, v146, s39
  v_fma_f32 v33, v33, s40, v28
  v_cvt_pk_bf16_f32 v120, v32, v33
  v_exp_f32 v27, v34 clamp
  v_max_f32 v34, s39, v34
  v_fma_f32 v35, v35, v147, s39
  v_fma_f32 v34, v34, s40, v27
  v_exp_f32 v28, v35 clamp
  v_max_f32 v35, s39, v35
  v_fma_f32 v36, v36, v148, s39
  v_fma_f32 v35, v35, s40, v28
  v_cvt_pk_bf16_f32 v121, v34, v35
  v_exp_f32 v27, v36 clamp
  v_max_f32 v36, s39, v36
  v_fma_f32 v37, v37, v149, s39
  v_fma_f32 v36, v36, s40, v27
  v_exp_f32 v28, v37 clamp
  v_max_f32 v37, s39, v37
  v_fma_f32 v38, v38, v150, s39
  v_fma_f32 v37, v37, s40, v28
  v_cvt_pk_bf16_f32 v122, v36, v37
  v_exp_f32 v27, v38 clamp
  v_max_f32 v38, s39, v38
  v_fma_f32 v39, v39, v151, s39
  v_fma_f32 v38, v38, s40, v27
  v_exp_f32 v28, v39 clamp
  v_max_f32 v39, s39, v39
  v_fma_f32 v40, v40, v152, s39
  v_fma_f32 v39, v39, s40, v28
  v_cvt_pk_bf16_f32 v123, v38, v39
  v_exp_f32 v27, v40 clamp
  v_max_f32 v40, s39, v40
  v_fma_f32 v41, v41, v153, s39
  v_fma_f32 v40, v40, s40, v27
  v_exp_f32 v28, v41 clamp
  v_max_f32 v41, s39, v41
  v_fma_f32 v42, v42, v154, s39
  v_fma_f32 v41, v41, s40, v28
  v_cvt_pk_bf16_f32 v124, v40, v41
  v_exp_f32 v27, v42 clamp
  v_max_f32 v42, s39, v42
  v_fma_f32 v43, v43, v155, s39
  v_fma_f32 v42, v42, s40, v27
  v_exp_f32 v28, v43 clamp
  v_max_f32 v43, s39, v43
  v_fma_f32 v44, v44, v156, s39
  v_fma_f32 v43, v43, s40, v28
  v_cvt_pk_bf16_f32 v125, v42, v43
  v_exp_f32 v27, v44 clamp
  v_max_f32 v44, s39, v44
  v_fma_f32 v45, v45, v157, s39
  v_fma_f32 v44, v44, s40, v27
  v_exp_f32 v28, v45 clamp
  v_max_f32 v45, s39, v45
  v_fma_f32 v46, v46, v158, s39
  v_fma_f32 v45, v45, s40, v28
  v_cvt_pk_bf16_f32 v126, v44, v45
  v_exp_f32 v27, v46 clamp
  v_max_f32 v46, s39, v46
  v_fma_f32 v47, v47, v159, s39
  v_fma_f32 v46, v46, s40, v27
  v_exp_f32 v28, v47 clamp
  v_max_f32 v47, s39, v47
  v_fma_f32 v47, v47, s40, v28
  v_cvt_pk_bf16_f32 v127, v46, v47
  v_mfma_f32_32x32x16_bf16 v[32:47], v[120:123], v[132:135], 0
  s_nop 0
  v_mfma_f32_32x32x16_bf16 v[32:47], v[124:127], v[136:139], v[32:47]
  v_mfma_f32_32x32x16_bf16 v[48:63], v[120:123], v[80:83], 0
  v_mfma_f32_32x32x16_bf16 v[48:63], v[124:127], v[80:83], v[48:63]
  s_nop 9
  v_cndmask_b32 v32, v32, v40, s[58:59]
  v_cndmask_b32 v33, v33, v41, s[58:59]
  v_cndmask_b32 v34, v34, v42, s[58:59]
  v_cndmask_b32 v35, v35, v43, s[58:59]
  v_cndmask_b32 v36, v36, v44, s[58:59]
  v_cndmask_b32 v37, v37, v45, s[58:59]
  v_cndmask_b32 v38, v38, v46, s[58:59]
  v_cndmask_b32 v39, v39, v47, s[58:59]
  ds_write_b128 v5, v[32:35]
  ds_write_b128 v5, v[36:39] offset:16
  v_cndmask_b32 v48, v48, v56, s[58:59]
  v_cndmask_b32 v49, v49, v57, s[58:59]
  v_cndmask_b32 v50, v50, v58, s[58:59]
  v_cndmask_b32 v51, v51, v59, s[58:59]
  v_cndmask_b32 v52, v52, v60, s[58:59]
  v_cndmask_b32 v53, v53, v61, s[58:59]
  v_cndmask_b32 v54, v54, v62, s[58:59]
  v_cndmask_b32 v55, v55, v63, s[58:59]
  ds_write_b128 v6, v[48:51]
  ds_write_b128 v6, v[52:55] offset:16
  s_waitcnt vmcnt(0)
  s_waitcnt lgkmcnt(0)
  s_barrier
  ds_read_b128 v[32:35], v7
  ds_read_b128 v[36:39], v7 offset:2304
  ds_read_b128 v[40:43], v7 offset:4608
  ds_read_b128 v[44:47], v7 offset:6912
  s_waitcnt lgkmcnt(2)
  v_pk_add_f32 v[32:33], v[32:33], v[36:37]
  s_waitcnt lgkmcnt(0)
  v_pk_add_f32 v[40:41], v[40:41], v[44:45]
  v_pk_add_f32 v[34:35], v[34:35], v[38:39]
  v_pk_add_f32 v[42:43], v[42:43], v[46:47]
  v_pk_add_f32 v[32:33], v[32:33], v[40:41]
  v_pk_add_f32 v[34:35], v[34:35], v[42:43]
  s_mov_b64 exec, s[56:57]
  buffer_store_dwordx4 v[32:35], v128, s[4:7], s34 offen sc1
  s_mov_b64 exec, -1
  ds_read_b128 v[96:99], v2 offset:16384
  ds_read_b128 v[100:103], v2 offset:17408
  ds_read_b128 v[104:107], v2 offset:18432
  ds_read_b128 v[108:111], v2 offset:19456
  ds_read_b128 v[112:115], v2 offset:20480
  s_waitcnt lgkmcnt(4)
  v_mfma_f32_32x32x16_bf16 v[64:79], v[96:99], a[0:3], 0
  s_add_u32 s46, s20, 1646592
  buffer_load_dwordx2 v[84:85], v11, s[4:7], s46 offen offset:2048 sc1
  buffer_load_dwordx2 v[86:87], v11, s[4:7], s46 offen offset:2304 sc1
  ds_read_b128 v[116:119], v2 offset:21504
  s_waitcnt lgkmcnt(4)
  v_mfma_f32_32x32x16_bf16 v[64:79], v[100:103], a[4:7], v[64:79]
  ds_read_b128 v[96:99], v2 offset:22528
  s_waitcnt lgkmcnt(4)
  v_mfma_f32_32x32x16_bf16 v[64:79], v[104:107], a[8:11], v[64:79]
  s_add_u32 s46, s32, 26738688
  buffer_load_dwordx4 v[136:139], v1, s[4:7], s46 offen sc1
  ds_read_b128 v[100:103], v2 offset:23552
  s_waitcnt lgkmcnt(4)
  v_mfma_f32_32x32x16_bf16 v[64:79], v[108:111], a[12:15], v[64:79]
  ds_read_b128 v[104:107], v2 offset:24576
  s_waitcnt lgkmcnt(4)
  v_mfma_f32_32x32x16_bf16 v[64:79], v[112:115], a[16:19], v[64:79]
  buffer_load_dwordx4 v[140:143], v1, s[4:7], s46 offen offset:1024 sc1
  ds_read_b128 v[108:111], v2 offset:25600
  s_waitcnt lgkmcnt(4)
  v_mfma_f32_32x32x16_bf16 v[64:79], v[116:119], a[20:23], v[64:79]
  ds_read_b128 v[112:115], v2 offset:26624
  s_waitcnt lgkmcnt(4)
  v_mfma_f32_32x32x16_bf16 v[64:79], v[96:99], a[24:27], v[64:79]
  ds_read_b128 v[116:119], v2 offset:27648
  s_waitcnt lgkmcnt(4)
  v_mfma_f32_32x32x16_bf16 v[64:79], v[100:103], a[28:31], v[64:79]
  ds_read_b128 v[96:99], v2 offset:28672
  s_waitcnt lgkmcnt(4)
  v_mfma_f32_32x32x16_bf16 v[64:79], v[104:107], a[32:35], v[64:79]
  ds_read_b128 v[100:103], v2 offset:29696
  s_waitcnt lgkmcnt(4)
  v_mfma_f32_32x32x16_bf16 v[64:79], v[108:111], a[36:39], v[64:79]
  ds_read_b128 v[104:107], v2 offset:30720
  s_waitcnt lgkmcnt(4)
  v_mfma_f32_32x32x16_bf16 v[64:79], v[112:115], a[40:43], v[64:79]
  ds_read_b128 v[108:111], v2 offset:31744
  s_waitcnt lgkmcnt(4)
  v_mfma_f32_32x32x16_bf16 v[64:79], v[116:119], a[44:47], v[64:79]
  ds_read_b128 v[112:115], v2 offset:32768
  s_waitcnt lgkmcnt(4)
  v_mfma_f32_32x32x16_bf16 v[64:79], v[96:99], a[48:51], v[64:79]
  ds_read_b128 v[116:119], v2 offset:33792
  s_waitcnt lgkmcnt(4)
  v_mfma_f32_32x32x16_bf16 v[64:79], v[100:103], a[52:55], v[64:79]
  ds_read_b128 v[96:99], v2 offset:34816
  s_waitcnt lgkmcnt(4)
  v_mfma_f32_32x32x16_bf16 v[64:79], v[104:107], a[56:59], v[64:79]
  ds_read_b128 v[100:103], v2 offset:35840
  s_waitcnt lgkmcnt(4)
  v_mfma_f32_32x32x16_bf16 v[64:79], v[108:111], a[60:63], v[64:79]
  ds_read_b128 v[104:107], v2 offset:36864
  s_waitcnt lgkmcnt(4)
  v_mfma_f32_32x32x16_bf16 v[64:79], v[112:115], a[64:67], v[64:79]
  ds_read_b128 v[108:111], v2 offset:37888
  s_waitcnt lgkmcnt(4)
  v_mfma_f32_32x32x16_bf16 v[64:79], v[116:119], a[68:71], v[64:79]
  ds_read_b128 v[112:115], v2 offset:38912
  s_waitcnt lgkmcnt(4)
  v_mfma_f32_32x32x16_bf16 v[64:79], v[96:99], a[72:75], v[64:79]
  ds_read_b128 v[116:119], v2 offset:39936
  s_waitcnt lgkmcnt(4)
  v_mfma_f32_32x32x16_bf16 v[64:79], v[100:103], a[76:79], v[64:79]
  ds_read_b128 v[96:99], v2 offset:40960
  s_waitcnt lgkmcnt(4)
  v_mfma_f32_32x32x16_bf16 v[64:79], v[104:107], a[80:83], v[64:79]
  ds_read_b128 v[100:103], v2 offset:41984
  s_waitcnt lgkmcnt(4)
  v_mfma_f32_32x32x16_bf16 v[64:79], v[108:111], a[84:87], v[64:79]
  ds_read_b128 v[104:107], v2 offset:43008
  s_waitcnt lgkmcnt(4)
  v_mfma_f32_32x32x16_bf16 v[64:79], v[112:115], a[88:91], v[64:79]
  ds_read_b128 v[108:111], v2 offset:44032
  s_waitcnt lgkmcnt(4)
  v_mfma_f32_32x32x16_bf16 v[64:79], v[116:119], a[92:95], v[64:79]
  ds_read_b128 v[112:115], v2 offset:45056
  s_waitcnt lgkmcnt(4)
  v_mfma_f32_32x32x16_bf16 v[64:79], v[96:99], a[96:99], v[64:79]
  ds_read_b128 v[116:119], v2 offset:46080
  s_waitcnt lgkmcnt(4)
  v_mfma_f32_32x32x16_bf16 v[64:79], v[100:103], a[100:103], v[64:79]
  ds_read_b128 v[96:99], v2 offset:47104
  s_waitcnt lgkmcnt(4)
  v_mfma_f32_32x32x16_bf16 v[64:79], v[104:107], a[104:107], v[64:79]
  ds_read_b128 v[100:103], v2 offset:48128
  s_waitcnt lgkmcnt(4)
  v_mfma_f32_32x32x16_bf16 v[64:79], v[108:111], a[108:111], v[64:79]
  s_waitcnt lgkmcnt(3)
  v_mfma_f32_32x32x16_bf16 v[64:79], v[112:115], a[112:115], v[64:79]
  s_waitcnt lgkmcnt(2)
  v_mfma_f32_32x32x16_bf16 v[64:79], v[116:119], a[116:119], v[64:79]
  s_waitcnt lgkmcnt(1)
  v_mfma_f32_32x32x16_bf16 v[64:79], v[96:99], a[120:123], v[64:79]
  s_waitcnt lgkmcnt(0)
  v_mfma_f32_32x32x16_bf16 v[64:79], v[100:103], a[124:127], v[64:79]
  s_waitcnt vmcnt(2)
  v_mfma_f32_32x32x16_bf16 v[64:79], v[84:87], v[20:23], v[64:79]
  s_nop 11
  s_branch L_body
L_main_final_80:
  s_nop 3
  v_and_b32 v27, 31, v0
  v_lshlrev_b32 v27, 10, v27
  v_lshrrev_b32 v28, 5, v0
  v_lshl_add_u32 v26, v28, 4, v27
  v_permlane32_swap_b32 v48, v50
  v_permlane32_swap_b32 v49, v51
  buffer_store_dwordx4 v[48:51], v26, s[8:11], s38 offen
  v_permlane32_swap_b32 v52, v54
  v_permlane32_swap_b32 v53, v55
  buffer_store_dwordx4 v[52:55], v26, s[8:11], s38 offen offset:32
L_main_end_1:
  s_endpgm
L_main_pkl_13:
  buffer_load_dword v30, v250, s[4:7], 0 offen sc1
  s_add_u32 s63, s63, 1
  s_waitcnt vmcnt(0)
  v_cmp_gt_u32 s[64:65], v251, v30
  s_cmp_ge_u32 s63, 4194304
  s_cbranch_scc1 L_main_pkd_14
  s_nop 3
  s_cmp_lg_u64 s[64:65], 0
  s_cbranch_scc1 L_main_pkl_13
  s_branch L_main_pkd_14
L_main_gretry_16:
  s_add_u32 s63, s63, 1
  s_cmp_ge_u32 s63, 4194304
  s_cbranch_scc1 L_main_gok_17
  buffer_load_dwordx2 v[80:81], v130, s[4:7], s41 offen sc1
  s_add_u32 s44, s35, 38797312
  buffer_load_dwordx4 v[32:35], v129, s[4:7], s44 offen sc1
  s_add_u32 s44, s35, 38801408
  buffer_load_dwordx4 v[36:39], v129, s[4:7], s44 offen sc1
  s_add_u32 s44, s35, 38805504
  buffer_load_dwordx4 v[40:43], v129, s[4:7], s44 offen sc1
  s_add_u32 s44, s35, 38809600
  buffer_load_dwordx4 v[44:47], v129, s[4:7], s44 offen sc1
  s_add_u32 s44, s35, 38813696
  buffer_load_dwordx4 v[48:51], v129, s[4:7], s44 offen sc1
  s_add_u32 s44, s35, 38817792
  buffer_load_dwordx4 v[52:55], v129, s[4:7], s44 offen sc1
  s_add_u32 s44, s35, 38821888
  buffer_load_dwordx4 v[56:59], v129, s[4:7], s44 offen sc1
  s_add_u32 s44, s35, 38825984
  buffer_load_dwordx4 v[60:63], v129, s[4:7], s44 offen sc1
  s_waitcnt vmcnt(0)
  s_branch L_main_gsum_15
L_main_pslow_19:
  buffer_store_dword v29, off, s[4:7], s100 sc1
  s_branch L_main_pdone_20
L_main_floop_21:
  buffer_load_dword v30, v9, s[4:7], 0 offen sc1
  s_add_u32 s63, s63, 1
  s_waitcnt vmcnt(0)
  v_cmp_gt_u32 s[64:65], s62, v30
  s_cmp_ge_u32 s63, 4194304
  s_cbranch_scc1 L_main_finv_23
  s_nop 3
  s_cmp_lg_u64 s[64:65], 0
  s_cbranch_scc1 L_main_floop_21
  s_branch L_main_finv_23
L_main_pkg_27:
  s_mov_b32 s63, 0
  s_branch L_main_pkm_30
L_main_pkl_28:
  buffer_load_dword v30, v250, s[4:7], 0 offen sc1
L_main_pkm_30:
  s_add_u32 s63, s63, 1
  s_waitcnt vmcnt(0)
  v_cmp_gt_u32 s[64:65], v251, v30
  s_cmp_ge_u32 s63, 4194304
  s_cbranch_scc1 L_main_pkf_29
  s_nop 3
  s_cmp_lg_u64 s[64:65], 0
  s_cbranch_scc1 L_main_pkl_28
  s_branch L_main_pkf_29
L_main_pslow_37:
  buffer_store_dword v29, off, s[4:7], s101 sc1
  s_branch L_main_pdone_38
L_main_floop_45:
  buffer_load_dword v30, v10, s[4:7], 0 offen sc1
  s_add_u32 s63, s63, 1
  s_waitcnt vmcnt(0)
  v_cmp_gt_u32 s[64:65], s62, v30
  s_cmp_ge_u32 s63, 4194304
  s_cbranch_scc1 L_main_finv_47
  s_nop 3
  s_cmp_lg_u64 s[64:65], 0
  s_cbranch_scc1 L_main_floop_45
  s_branch L_main_finv_47
L_main_pslow_63:
  buffer_store_dword v29, off, s[4:7], s100 sc1
  s_branch L_main_pdone_64
L_main_floop_65:
  buffer_load_dword v30, v9, s[4:7], 0 offen sc1
  s_add_u32 s63, s63, 1
  s_waitcnt vmcnt(0)
  v_cmp_gt_u32 s[64:65], s62, v30
  s_cmp_ge_u32 s63, 4194304
  s_cbranch_scc1 L_main_finv_67
  s_nop 3
  s_cmp_lg_u64 s[64:65], 0
  s_cbranch_scc1 L_main_floop_65
  s_branch L_main_finv_67
L_main_pslow_70:
  buffer_store_dword v29, off, s[4:7], s100 sc1
  s_branch L_main_pdone_71
L_main_floop_72:
  buffer_load_dword v30, v9, s[4:7], 0 offen sc1
  s_add_u32 s63, s63, 1
  s_waitcnt vmcnt(0)
  v_cmp_gt_u32 s[64:65], s62, v30
  s_cmp_ge_u32 s63, 4194304
  s_cbranch_scc1 L_main_finv_74
  s_nop 3
  s_cmp_lg_u64 s[64:65], 0
  s_cbranch_scc1 L_main_floop_72
  s_branch L_main_finv_74
L_main_pslow_81:
  buffer_store_dword v29, off, s[4:7], s101 sc1
  s_branch L_main_pdone_82
L_main_floop_83:
  buffer_load_dword v30, v10, s[4:7], 0 offen sc1
  s_add_u32 s63, s63, 1
  s_waitcnt vmcnt(0)
  v_cmp_gt_u32 s[64:65], s62, v30
  s_cmp_ge_u32 s63, 4194304
  s_cbranch_scc1 L_main_finv_85
  s_nop 3
  s_cmp_lg_u64 s[64:65], 0
  s_cbranch_scc1 L_main_floop_83
  s_branch L_main_finv_85
L_code_end:
.section .rodata,"a"
.p2align 6
.amdhsa_kernel interleave_layers__linear_attn_block__glu_gated_bilinear__prompt_kernel
  .amdhsa_next_free_vgpr 512
  .amdhsa_next_free_sgpr 102
  .amdhsa_accum_offset 256
  .amdhsa_group_segment_fixed_size 0
  .amdhsa_kernarg_size 80
  .amdhsa_user_sgpr_count 2
  .amdhsa_user_sgpr_kernarg_segment_ptr 1
  .amdhsa_system_sgpr_workgroup_id_x 1
.end_amdhsa_kernel
```
